```python
import torch

def _softmax(x, axis=-1):
    return torch.softmax(x, dim=axis)
def _gelu(x):
    return torch.nn.functional.gelu(x, approximate="tanh")
def _silu(x):
    return torch.nn.functional.silu(x)
def _sigmoid(x):
    return torch.sigmoid(x)
def _layernorm(x, axis=-1, eps=1e-5):
    m = x.mean(dim=axis, keepdim=True)
    v = x.var(dim=axis, keepdim=True, unbiased=False)
    return (x - m) / torch.sqrt(v + eps)
def _scatter_add(tgt, idx, src, axis=0):
    return tgt.clone().index_add_(axis, idx, src)
def _segment_sum(src, seg, n):
    out = torch.zeros((n,) + src.shape[1:], dtype=src.dtype)
    return out.index_add_(0, seg, src)
def _pad(x, pw):
    flat = tuple(v for pair in reversed(pw) for v in pair)
    return torch.nn.functional.pad(x, flat)

kernel_name = 'parallel_sum__mha_block_cached__dense_activation_silu__decode'

def setup_inputs():

    _w = (lambda a: (lambda t: t.to(torch.bfloat16) if t.is_floating_point() else t)(torch.as_tensor(a)))
    def _A_setup():
        B, Sq, D = 8, 1, 512
        H, Sk, Dh = 32, 4096, 128
        return {
            "x": _w((lambda *s: torch.randn(*s, dtype=torch.bfloat16) * 0.05)(B, Sq, D)),
            "k_cache": _w((lambda *s: torch.randn(*s, dtype=torch.bfloat16) * 3.2)(B, H, Sk, Dh)),
            "v_cache": _w((lambda *s: torch.randn(*s, dtype=torch.bfloat16) * 0.8)(B, H, Sk, Dh)),
            "wq": _w((lambda *s: torch.randn(*s, dtype=torch.bfloat16) * 3.2)(D, H * Dh) * (D ** -0.5)),
            "wo": _w((lambda *s: torch.randn(*s, dtype=torch.bfloat16) * 0.8)(H * Dh, D) * ((H * Dh) ** -0.5)),
        }
    _A_in = _A_setup()

    def _B_setup():
        B, S, D, F = 8, 1, 512, 1792
        return {
            "x": _w((lambda *s: torch.randn(*s, dtype=torch.bfloat16) * 0.05)(B, S, D)),
            "w1": _w((lambda *s: torch.randn(*s, dtype=torch.bfloat16) * 3.2)(D, F) * (D ** -0.5)),
            "w2": _w((lambda *s: torch.randn(*s, dtype=torch.bfloat16) * 0.4)(F, D) * (F ** -0.5)),
        }
    _B_in = _B_setup()

    return {
        "A_x": _A_in["x"],
        "A_k_cache": _A_in["k_cache"],
        "A_v_cache": _A_in["v_cache"],
        "A_wq": _A_in["wq"],
        "A_wo": _A_in["wo"],
        "B_x": _B_in["x"],
        "B_w1": _B_in["w1"],
        "B_w2": _B_in["w2"],
    }

def reference(A_x, A_k_cache, A_v_cache, A_wq, A_wo, B_x, B_w1, B_w2):
    def _A_ref(x, k_cache, v_cache, wq, wo):
        B, Sq, D = x.shape
        H, Dh = 32, 128
        q = (lambda x, *d: x.permute(*d))((x @ wq).reshape(B, Sq, H, Dh), 0, 2, 1, 3)
        scores = torch.einsum("bhqd,bhkd->bhqk", q, k_cache) * (Dh ** -0.5)
        p = _softmax(scores, axis=-1)
        o = torch.einsum("bhqk,bhkd->bhqd", p, v_cache)
        return (lambda x, *d: x.permute(*d))(o, 0, 2, 1, 3).reshape(B, Sq, H * Dh) @ wo

    def _B_ref(x, w1, w2):
        h = torch.einsum("bsd,df->bsf", x, w1)
        h = _silu(h)
        out = torch.einsum("bsf,fd->bsd", h, w2)
        return out

    x = A_x
    xn = _layernorm(x, axis=-1)
    return x + _A_ref(xn, A_k_cache, A_v_cache, A_wq, A_wo) + _B_ref(xn, B_w1, B_w2)
```

```asm
; @launch grid=(256,1,1) block=(448,1,1) lds=161536
.amdgcn_target "amdgcn-amd-amdhsa--gfx950"
.text
.p2align 12
.globl parallel_sum__mha_block_cached__dense_activation_silu__decode_kernel
.p2align 8
.type parallel_sum__mha_block_cached__dense_activation_silu__decode_kernel,@function
parallel_sum__mha_block_cached__dense_activation_silu__decode_kernel:
    v_lshrrev_b32 v1, 6, v0
    s_cmp_ge_u32 s2, 256
    s_cbranch_scc1 L_end
    v_readfirstlane_b32 s3, v1
    v_and_b32 v0, 63, v0
    s_mov_b32 s7, 0x100000
    s_cmp_eq_u32 s3, 1
    s_cbranch_scc0 L_args
    v_lshlrev_b32 v2, 2, v0
    v_add_u32 v2, 155904, v2
    v_mov_b32 v4, 0
    v_mov_b32 v5, 3
    ds_write2st64_b32 v2, v4, v4 offset0:0 offset1:1
    ds_write2st64_b32 v2, v5, v4 offset0:2 offset1:3
    s_waitcnt lgkmcnt(0)
    s_barrier
    s_branch L_consumer
L_args:
    s_load_dwordx16 s[36:51], s[0:1], 0
    s_load_dwordx4 s[52:55], s[0:1], 64
    s_load_dwordx2 s[56:57], s[0:1], 80
    s_barrier
    s_cmp_lg_u32 s3, 0
    s_cbranch_scc1 L_roles
    s_setprio 3
    v_lshlrev_b32 v16, 4, v0
    v_lshlrev_b32 v2, 2, v0
    v_add_u32 v2, 155904, v2
    v_xor_b32 v20, 64, v16
    v_xor_b32 v24, 0x80, v16
    v_xor_b32 v28, 64, v24
    v_xor_b32 v17, 16, v16
    v_xor_b32 v18, 32, v16
    v_xor_b32 v19, 48, v16
    v_xor_b32 v21, 16, v20
    v_xor_b32 v22, 32, v20
    v_xor_b32 v23, 48, v20
    v_xor_b32 v25, 16, v24
    v_xor_b32 v26, 32, v24
    v_xor_b32 v27, 48, v24
    v_xor_b32 v29, 16, v28
    v_xor_b32 v30, 32, v28
    v_xor_b32 v31, 48, v28
    v_mov_b32 v3, 156160
    s_lshl_b32 s6, s2, 20
    s_mov_b32 s18, 0x100000
    s_mov_b32 s19, 0x20000
    s_mov_b64 s[24:25], 0
    s_mov_b32 s26, 0
    s_mov_b32 s27, -8
    s_mov_b32 s28, 0
    s_mov_b32 s29, 48
    s_waitcnt lgkmcnt(0)
    s_add_u32 s16, s38, s6
    s_addc_u32 s17, s39, 0
    s_and_b32 s17, s17, 0xffff
    .p2align 3
L_ld_d3:
    s_add_u32 m0, s25, 0
    s_xor_b32 s23, s24, 0
    s_waitcnt vmcnt(18)
    buffer_load_dwordx4 v16, s[16:19], s23 offen offset:0 nt lds
    s_waitcnt vmcnt(18)
    buffer_load_dwordx4 v17, s[16:19], s23 offen offset:1024 nt lds
    s_waitcnt vmcnt(18)
    buffer_load_dwordx4 v18, s[16:19], s23 offen offset:2048 nt lds
    s_add_i32 s30, s28, -4
    v_mov_b32 v4, s30
    ds_write_b32 v2, v4
    s_waitcnt vmcnt(18)
    buffer_load_dwordx4 v19, s[16:19], s23 offen offset:3072 nt lds
    s_add_u32 m0, s25, 4096
    s_xor_b32 s23, s24, 8192
    s_waitcnt vmcnt(18)
    buffer_load_dwordx4 v20, s[16:19], s23 offen offset:0 nt lds
    s_waitcnt vmcnt(18)
    buffer_load_dwordx4 v21, s[16:19], s23 offen offset:1024 nt lds
    s_waitcnt vmcnt(18)
    buffer_load_dwordx4 v22, s[16:19], s23 offen offset:2048 nt lds
    s_add_i32 s30, s28, -3
    v_mov_b32 v4, s30
    ds_write_b32 v2, v4
    s_waitcnt vmcnt(18)
    buffer_load_dwordx4 v23, s[16:19], s23 offen offset:3072 nt lds
    s_add_u32 m0, s25, 8192
    s_xor_b32 s23, s24, 32768
    s_waitcnt vmcnt(18)
    buffer_load_dwordx4 v24, s[16:19], s23 offen offset:0 nt lds
    ds_read2st64_b32 v[6:7], v3 offset0:0 offset1:1
    s_waitcnt vmcnt(18)
    buffer_load_dwordx4 v25, s[16:19], s23 offen offset:1024 nt lds
    s_waitcnt vmcnt(18)
    buffer_load_dwordx4 v26, s[16:19], s23 offen offset:2048 nt lds
    s_add_i32 s30, s28, -2
    v_mov_b32 v4, s30
    ds_write_b32 v2, v4
    s_waitcnt vmcnt(18)
    buffer_load_dwordx4 v27, s[16:19], s23 offen offset:3072 nt lds
    s_add_u32 m0, s25, 12288
    s_xor_b32 s23, s24, 40960
    s_waitcnt vmcnt(18)
    buffer_load_dwordx4 v28, s[16:19], s23 offen offset:0 nt lds
    s_waitcnt lgkmcnt(0)
    v_readfirstlane_b32 s26, v6
    v_readfirstlane_b32 s31, v7
    s_waitcnt vmcnt(18)
    buffer_load_dwordx4 v29, s[16:19], s23 offen offset:1024 nt lds
    s_waitcnt vmcnt(18)
    buffer_load_dwordx4 v30, s[16:19], s23 offen offset:2048 nt lds
    s_add_i32 s30, s28, -1
    v_mov_b32 v4, s30
    ds_write_b32 v2, v4
    s_waitcnt vmcnt(18)
    buffer_load_dwordx4 v31, s[16:19], s23 offen offset:3072 nt lds
    s_branch L_ld_top
L_roles:
    s_cmp_eq_u32 s3, 6
    s_cbranch_scc1 L_aux
    s_sub_u32 s33, s3, 2
    s_lshr_b32 s4, s2, 5
    s_and_b32 s5, s2, 31
    v_lshrrev_b32 v9, 4, v0
    v_and_b32 v10, 15, v0
    s_lshl_b32 s6, s4, 10
    v_lshlrev_b32 v3, 4, v0
    v_add_u32 v3, s6, v3
    s_lshl_b32 s90, s4, 1
    v_xor_b32 v8, s90, v10
    v_lshlrev_b32 v8, 4, v8
    v_lshl_add_u32 v8, v9, 8, v8
    s_lshl_b32 s34, s33, 2
    s_add_u32 s34, s34, s6
    s_lshl_b32 s6, s33, 14
    s_lshl_b32 s35, s5, 8
    s_add_u32 s6, s6, s35
    v_lshlrev_b32 v2, 20, v9
    v_lshl_add_u32 v2, v10, 4, v2
    v_add_u32 v18, s6, v2
    s_lshl_b32 s91, s90, 16
    s_waitcnt lgkmcnt(0)
    s_mov_b32 s8, s36
    s_and_b32 s9, s37, 0xffff
    s_mov_b32 s10, 0x2000
    s_mov_b32 s11, 0x20000
    s_mov_b32 s12, s42
    s_and_b32 s13, s43, 0xffff
    s_mov_b32 s14, 0x400000
    s_mov_b32 s15, 0x20000
    buffer_load_dwordx4 v[4:7], v3, s[8:11], 0 offen
    buffer_load_dword v8, v8, s[8:11], s34 offen
    s_xor_b32 s59, s91, 0
    buffer_load_dwordx4 v[32:35], v18, s[12:15], s59 offen
    s_xor_b32 s59, s91, 8192
    buffer_load_dwordx4 v[36:39], v18, s[12:15], s59 offen
    s_xor_b32 s59, s91, 65536
    buffer_load_dwordx4 v[40:43], v18, s[12:15], s59 offen
    v_and_b32 v1, 1, v0
    v_lshlrev_b32 v1, 4, v1
    v_mov_b32 v2, 0xffff
    v_lshlrev_b32 v1, v1, v2
    v_bfe_u32 v2, v0, 1, 2
    v_cmp_eq_u32 vcc, 0, v2
    s_nop 1
    v_cndmask_b32 v12, 0, v1, vcc
    v_cmp_eq_u32 vcc, 1, v2
    s_nop 1
    v_cndmask_b32 v13, 0, v1, vcc
    v_cmp_eq_u32 vcc, 2, v2
    s_nop 1
    v_cndmask_b32 v14, 0, v1, vcc
    v_cmp_eq_u32 vcc, 3, v2
    s_nop 1
    v_cndmask_b32 v15, 0, v1, vcc
    s_waitcnt vmcnt(2)
    s_xor_b32 s59, s91, 73728
    buffer_load_dwordx4 v[44:47], v18, s[12:15], s59 offen
    s_waitcnt vmcnt(2)
    s_xor_b32 s59, s91, 131072
    buffer_load_dwordx4 v[48:51], v18, s[12:15], s59 offen
    s_waitcnt vmcnt(2)
    s_xor_b32 s59, s91, 139264
    buffer_load_dwordx4 v[52:55], v18, s[12:15], s59 offen
    v_lshlrev_b32 v160, 16, v4
    v_and_b32 v161, 0xffff0000, v4
    v_lshlrev_b32 v162, 16, v5
    v_and_b32 v163, 0xffff0000, v5
    v_lshlrev_b32 v164, 16, v6
    v_and_b32 v165, 0xffff0000, v6
    v_lshlrev_b32 v166, 16, v7
    v_and_b32 v167, 0xffff0000, v7
    v_add_f32 v1, v160, v161
    v_add_f32 v2, v162, v163
    v_add_f32 v3, v164, v165
    v_add_f32 v11, v166, v167
    v_add_f32 v1, v1, v2
    v_add_f32 v3, v3, v11
    v_add_f32 v1, v1, v3
    s_nop 1
    v_add_f32_dpp v1, v1, v1 row_ror:8 row_mask:0xf bank_mask:0xf
    s_nop 1
    v_add_f32_dpp v1, v1, v1 row_ror:4 row_mask:0xf bank_mask:0xf
    s_nop 1
    v_add_f32_dpp v1, v1, v1 row_ror:2 row_mask:0xf bank_mask:0xf
    s_nop 1
    v_add_f32_dpp v1, v1, v1 row_ror:1 row_mask:0xf bank_mask:0xf
    s_nop 1
    v_add_f32_dpp v1, v1, v1 row_bcast:15 row_mask:0xa bank_mask:0xf
    s_nop 1
    v_add_f32_dpp v1, v1, v1 row_bcast:31 row_mask:0xc bank_mask:0xf
    v_mul_f32 v1, 0x3b000000, v1
    s_nop 0
    v_readlane_b32 s6, v1, 63
    s_nop 1
    v_subrev_f32 v160, s6, v160
    v_subrev_f32 v161, s6, v161
    v_subrev_f32 v162, s6, v162
    v_subrev_f32 v163, s6, v163
    v_subrev_f32 v164, s6, v164
    v_subrev_f32 v165, s6, v165
    v_subrev_f32 v166, s6, v166
    v_subrev_f32 v167, s6, v167
    v_mul_f32 v1, v160, v160
    v_mul_f32 v2, v161, v161
    v_fmac_f32 v1, v162, v162
    v_fmac_f32 v2, v163, v163
    v_fmac_f32 v1, v164, v164
    v_fmac_f32 v2, v165, v165
    v_fmac_f32 v1, v166, v166
    v_fmac_f32 v2, v167, v167
    v_add_f32 v1, v1, v2
    s_nop 1
    v_add_f32_dpp v1, v1, v1 row_ror:8 row_mask:0xf bank_mask:0xf
    s_nop 1
    v_add_f32_dpp v1, v1, v1 row_ror:4 row_mask:0xf bank_mask:0xf
    s_nop 1
    v_add_f32_dpp v1, v1, v1 row_ror:2 row_mask:0xf bank_mask:0xf
    s_nop 1
    v_add_f32_dpp v1, v1, v1 row_ror:1 row_mask:0xf bank_mask:0xf
    s_nop 1
    v_add_f32_dpp v1, v1, v1 row_bcast:15 row_mask:0xa bank_mask:0xf
    s_nop 1
    v_add_f32_dpp v1, v1, v1 row_bcast:31 row_mask:0xc bank_mask:0xf
    v_mul_f32 v1, 0x3b000000, v1
    s_nop 0
    v_readlane_b32 s35, v1, 63
    v_mov_b32 v2, s6
    v_cvt_pk_bf16_f32 v2, v2, v2
    v_and_b32 v2, 0xffff0000, v2
    v_mov_b32 v1, s35
    v_cvt_pk_bf16_f32 v1, v1, v1
    v_and_b32 v1, 0xffff0000, v1
    v_add_f32 v1, 0x3727c5ac, v1
    v_cvt_pk_bf16_f32 v1, v1, v1
    v_and_b32 v1, 0xffff0000, v1
    v_sqrt_f32 v1, v1
    s_nop 0
    v_cvt_pk_bf16_f32 v1, v1, v1
    v_and_b32 v1, 0xffff0000, v1
    v_rcp_f32 v1, v1
    v_lshlrev_b32 v16, 16, v8
    v_and_b32 v17, 0xffff0000, v8
    v_sub_f32 v16, v16, v2
    v_sub_f32 v17, v17, v2
    v_cvt_pk_bf16_f32 v17, v16, v17
    v_lshlrev_b32 v16, 16, v17
    v_and_b32 v17, 0xffff0000, v17
    v_mul_f32 v16, v16, v1
    v_mul_f32 v17, v17, v1
    v_cvt_pk_bf16_f32 v16, v16, v16
    v_cvt_pk_bf16_f32 v17, v17, v17
    v_lshlrev_b32 v11, 5, v10
    v_and_b32 v1, 16, v0
    v_add_u32 v11, v11, v1
    s_lshl_b32 s6, s33, 9
    v_add_u32 v11, s6, v11
    v_add_u32 v3, 156928, v11
    v_mov_b32 v19, 1
    v_and_b32_dpp v20, v16, v12 row_newbcast:0 row_mask:0xf bank_mask:0xf
    v_and_b32_dpp v21, v16, v13 row_newbcast:0 row_mask:0xf bank_mask:0xf
    v_and_b32_dpp v22, v16, v14 row_newbcast:0 row_mask:0xf bank_mask:0xf
    v_and_b32_dpp v23, v16, v15 row_newbcast:0 row_mask:0xf bank_mask:0xf
    s_nop 1
    v_mfma_f32_16x16x32_bf16 v[28:31], v[20:23], v[32:35], 0
    v_and_b32_dpp v24, v17, v12 row_newbcast:0 row_mask:0xf bank_mask:0xf
    v_and_b32_dpp v25, v17, v13 row_newbcast:0 row_mask:0xf bank_mask:0xf
    v_and_b32_dpp v26, v17, v14 row_newbcast:0 row_mask:0xf bank_mask:0xf
    v_and_b32_dpp v27, v17, v15 row_newbcast:0 row_mask:0xf bank_mask:0xf
    s_nop 1
    v_mfma_f32_16x16x32_bf16 v[28:31], v[24:27], v[36:39], v[28:31]
    v_and_b32_dpp v20, v16, v12 row_newbcast:1 row_mask:0xf bank_mask:0xf
    v_and_b32_dpp v21, v16, v13 row_newbcast:1 row_mask:0xf bank_mask:0xf
    v_and_b32_dpp v22, v16, v14 row_newbcast:1 row_mask:0xf bank_mask:0xf
    v_and_b32_dpp v23, v16, v15 row_newbcast:1 row_mask:0xf bank_mask:0xf
    s_nop 1
    v_mfma_f32_16x16x32_bf16 v[28:31], v[20:23], v[40:43], v[28:31]
    v_and_b32_dpp v24, v17, v12 row_newbcast:1 row_mask:0xf bank_mask:0xf
    v_and_b32_dpp v25, v17, v13 row_newbcast:1 row_mask:0xf bank_mask:0xf
    v_and_b32_dpp v26, v17, v14 row_newbcast:1 row_mask:0xf bank_mask:0xf
    v_and_b32_dpp v27, v17, v15 row_newbcast:1 row_mask:0xf bank_mask:0xf
    s_waitcnt vmcnt(2)
    s_xor_b32 s59, s91, 196608
    buffer_load_dwordx4 v[56:59], v18, s[12:15], s59 offen
    v_mfma_f32_16x16x32_bf16 v[28:31], v[24:27], v[44:47], v[28:31]
    v_and_b32_dpp v20, v16, v12 row_newbcast:2 row_mask:0xf bank_mask:0xf
    v_and_b32_dpp v21, v16, v13 row_newbcast:2 row_mask:0xf bank_mask:0xf
    v_and_b32_dpp v22, v16, v14 row_newbcast:2 row_mask:0xf bank_mask:0xf
    v_and_b32_dpp v23, v16, v15 row_newbcast:2 row_mask:0xf bank_mask:0xf
    s_waitcnt vmcnt(2)
    s_xor_b32 s59, s91, 204800
    buffer_load_dwordx4 v[60:63], v18, s[12:15], s59 offen
    v_mfma_f32_16x16x32_bf16 v[28:31], v[20:23], v[48:51], v[28:31]
    v_and_b32_dpp v24, v17, v12 row_newbcast:2 row_mask:0xf bank_mask:0xf
    v_and_b32_dpp v25, v17, v13 row_newbcast:2 row_mask:0xf bank_mask:0xf
    v_and_b32_dpp v26, v17, v14 row_newbcast:2 row_mask:0xf bank_mask:0xf
    v_and_b32_dpp v27, v17, v15 row_newbcast:2 row_mask:0xf bank_mask:0xf
    s_waitcnt vmcnt(2)
    s_xor_b32 s59, s91, 262144
    buffer_load_dwordx4 v[64:67], v18, s[12:15], s59 offen
    v_mfma_f32_16x16x32_bf16 v[28:31], v[24:27], v[52:55], v[28:31]
    v_and_b32_dpp v20, v16, v12 row_newbcast:3 row_mask:0xf bank_mask:0xf
    v_and_b32_dpp v21, v16, v13 row_newbcast:3 row_mask:0xf bank_mask:0xf
    v_and_b32_dpp v22, v16, v14 row_newbcast:3 row_mask:0xf bank_mask:0xf
    v_and_b32_dpp v23, v16, v15 row_newbcast:3 row_mask:0xf bank_mask:0xf
    s_waitcnt vmcnt(2)
    s_xor_b32 s59, s91, 270336
    buffer_load_dwordx4 v[68:71], v18, s[12:15], s59 offen
    v_mfma_f32_16x16x32_bf16 v[28:31], v[20:23], v[56:59], v[28:31]
    v_and_b32_dpp v24, v17, v12 row_newbcast:3 row_mask:0xf bank_mask:0xf
    v_and_b32_dpp v25, v17, v13 row_newbcast:3 row_mask:0xf bank_mask:0xf
    v_and_b32_dpp v26, v17, v14 row_newbcast:3 row_mask:0xf bank_mask:0xf
    v_and_b32_dpp v27, v17, v15 row_newbcast:3 row_mask:0xf bank_mask:0xf
    s_waitcnt vmcnt(2)
    s_xor_b32 s59, s91, 327680
    buffer_load_dwordx4 v[72:75], v18, s[12:15], s59 offen
    v_mfma_f32_16x16x32_bf16 v[28:31], v[24:27], v[60:63], v[28:31]
    v_and_b32_dpp v20, v16, v12 row_newbcast:4 row_mask:0xf bank_mask:0xf
    v_and_b32_dpp v21, v16, v13 row_newbcast:4 row_mask:0xf bank_mask:0xf
    v_and_b32_dpp v22, v16, v14 row_newbcast:4 row_mask:0xf bank_mask:0xf
    v_and_b32_dpp v23, v16, v15 row_newbcast:4 row_mask:0xf bank_mask:0xf
    s_waitcnt vmcnt(2)
    s_xor_b32 s59, s91, 335872
    buffer_load_dwordx4 v[76:79], v18, s[12:15], s59 offen
    v_mfma_f32_16x16x32_bf16 v[28:31], v[20:23], v[64:67], v[28:31]
    v_and_b32_dpp v24, v17, v12 row_newbcast:4 row_mask:0xf bank_mask:0xf
    v_and_b32_dpp v25, v17, v13 row_newbcast:4 row_mask:0xf bank_mask:0xf
    v_and_b32_dpp v26, v17, v14 row_newbcast:4 row_mask:0xf bank_mask:0xf
    v_and_b32_dpp v27, v17, v15 row_newbcast:4 row_mask:0xf bank_mask:0xf
    s_waitcnt vmcnt(2)
    s_xor_b32 s59, s91, 393216
    buffer_load_dwordx4 v[80:83], v18, s[12:15], s59 offen
    v_mfma_f32_16x16x32_bf16 v[28:31], v[24:27], v[68:71], v[28:31]
    v_and_b32_dpp v20, v16, v12 row_newbcast:5 row_mask:0xf bank_mask:0xf
    v_and_b32_dpp v21, v16, v13 row_newbcast:5 row_mask:0xf bank_mask:0xf
    v_and_b32_dpp v22, v16, v14 row_newbcast:5 row_mask:0xf bank_mask:0xf
    v_and_b32_dpp v23, v16, v15 row_newbcast:5 row_mask:0xf bank_mask:0xf
    s_waitcnt vmcnt(2)
    s_xor_b32 s59, s91, 401408
    buffer_load_dwordx4 v[84:87], v18, s[12:15], s59 offen
    v_mfma_f32_16x16x32_bf16 v[28:31], v[20:23], v[72:75], v[28:31]
    v_and_b32_dpp v24, v17, v12 row_newbcast:5 row_mask:0xf bank_mask:0xf
    v_and_b32_dpp v25, v17, v13 row_newbcast:5 row_mask:0xf bank_mask:0xf
    v_and_b32_dpp v26, v17, v14 row_newbcast:5 row_mask:0xf bank_mask:0xf
    v_and_b32_dpp v27, v17, v15 row_newbcast:5 row_mask:0xf bank_mask:0xf
    s_waitcnt vmcnt(2)
    s_xor_b32 s59, s91, 458752
    buffer_load_dwordx4 v[88:91], v18, s[12:15], s59 offen
    v_mfma_f32_16x16x32_bf16 v[28:31], v[24:27], v[76:79], v[28:31]
    v_and_b32_dpp v20, v16, v12 row_newbcast:6 row_mask:0xf bank_mask:0xf
    v_and_b32_dpp v21, v16, v13 row_newbcast:6 row_mask:0xf bank_mask:0xf
    v_and_b32_dpp v22, v16, v14 row_newbcast:6 row_mask:0xf bank_mask:0xf
    v_and_b32_dpp v23, v16, v15 row_newbcast:6 row_mask:0xf bank_mask:0xf
    s_waitcnt vmcnt(2)
    s_xor_b32 s59, s91, 466944
    buffer_load_dwordx4 v[92:95], v18, s[12:15], s59 offen
    v_mfma_f32_16x16x32_bf16 v[28:31], v[20:23], v[80:83], v[28:31]
    v_and_b32_dpp v24, v17, v12 row_newbcast:6 row_mask:0xf bank_mask:0xf
    v_and_b32_dpp v25, v17, v13 row_newbcast:6 row_mask:0xf bank_mask:0xf
    v_and_b32_dpp v26, v17, v14 row_newbcast:6 row_mask:0xf bank_mask:0xf
    v_and_b32_dpp v27, v17, v15 row_newbcast:6 row_mask:0xf bank_mask:0xf
    s_waitcnt vmcnt(2)
    s_xor_b32 s59, s91, 524288
    buffer_load_dwordx4 v[96:99], v18, s[12:15], s59 offen
    v_mfma_f32_16x16x32_bf16 v[28:31], v[24:27], v[84:87], v[28:31]
    v_and_b32_dpp v20, v16, v12 row_newbcast:7 row_mask:0xf bank_mask:0xf
    v_and_b32_dpp v21, v16, v13 row_newbcast:7 row_mask:0xf bank_mask:0xf
    v_and_b32_dpp v22, v16, v14 row_newbcast:7 row_mask:0xf bank_mask:0xf
    v_and_b32_dpp v23, v16, v15 row_newbcast:7 row_mask:0xf bank_mask:0xf
    s_waitcnt vmcnt(2)
    s_xor_b32 s59, s91, 532480
    buffer_load_dwordx4 v[100:103], v18, s[12:15], s59 offen
    v_mfma_f32_16x16x32_bf16 v[28:31], v[20:23], v[88:91], v[28:31]
    v_and_b32_dpp v24, v17, v12 row_newbcast:7 row_mask:0xf bank_mask:0xf
    v_and_b32_dpp v25, v17, v13 row_newbcast:7 row_mask:0xf bank_mask:0xf
    v_and_b32_dpp v26, v17, v14 row_newbcast:7 row_mask:0xf bank_mask:0xf
    v_and_b32_dpp v27, v17, v15 row_newbcast:7 row_mask:0xf bank_mask:0xf
    s_waitcnt vmcnt(2)
    s_xor_b32 s59, s91, 589824
    buffer_load_dwordx4 v[104:107], v18, s[12:15], s59 offen
    v_mfma_f32_16x16x32_bf16 v[28:31], v[24:27], v[92:95], v[28:31]
    v_and_b32_dpp v20, v16, v12 row_newbcast:8 row_mask:0xf bank_mask:0xf
    v_and_b32_dpp v21, v16, v13 row_newbcast:8 row_mask:0xf bank_mask:0xf
    v_and_b32_dpp v22, v16, v14 row_newbcast:8 row_mask:0xf bank_mask:0xf
    v_and_b32_dpp v23, v16, v15 row_newbcast:8 row_mask:0xf bank_mask:0xf
    s_waitcnt vmcnt(2)
    s_xor_b32 s59, s91, 598016
    buffer_load_dwordx4 v[108:111], v18, s[12:15], s59 offen
    v_mfma_f32_16x16x32_bf16 v[28:31], v[20:23], v[96:99], v[28:31]
    v_and_b32_dpp v24, v17, v12 row_newbcast:8 row_mask:0xf bank_mask:0xf
    v_and_b32_dpp v25, v17, v13 row_newbcast:8 row_mask:0xf bank_mask:0xf
    v_and_b32_dpp v26, v17, v14 row_newbcast:8 row_mask:0xf bank_mask:0xf
    v_and_b32_dpp v27, v17, v15 row_newbcast:8 row_mask:0xf bank_mask:0xf
    s_waitcnt vmcnt(2)
    s_xor_b32 s59, s91, 655360
    buffer_load_dwordx4 v[112:115], v18, s[12:15], s59 offen
    v_mfma_f32_16x16x32_bf16 v[28:31], v[24:27], v[100:103], v[28:31]
    v_and_b32_dpp v20, v16, v12 row_newbcast:9 row_mask:0xf bank_mask:0xf
    v_and_b32_dpp v21, v16, v13 row_newbcast:9 row_mask:0xf bank_mask:0xf
    v_and_b32_dpp v22, v16, v14 row_newbcast:9 row_mask:0xf bank_mask:0xf
    v_and_b32_dpp v23, v16, v15 row_newbcast:9 row_mask:0xf bank_mask:0xf
    s_waitcnt vmcnt(2)
    s_xor_b32 s59, s91, 663552
    buffer_load_dwordx4 v[116:119], v18, s[12:15], s59 offen
    v_mfma_f32_16x16x32_bf16 v[28:31], v[20:23], v[104:107], v[28:31]
    v_and_b32_dpp v24, v17, v12 row_newbcast:9 row_mask:0xf bank_mask:0xf
    v_and_b32_dpp v25, v17, v13 row_newbcast:9 row_mask:0xf bank_mask:0xf
    v_and_b32_dpp v26, v17, v14 row_newbcast:9 row_mask:0xf bank_mask:0xf
    v_and_b32_dpp v27, v17, v15 row_newbcast:9 row_mask:0xf bank_mask:0xf
    s_waitcnt vmcnt(2)
    s_xor_b32 s59, s91, 720896
    buffer_load_dwordx4 v[120:123], v18, s[12:15], s59 offen
    v_mfma_f32_16x16x32_bf16 v[28:31], v[24:27], v[108:111], v[28:31]
    v_and_b32_dpp v20, v16, v12 row_newbcast:10 row_mask:0xf bank_mask:0xf
    v_and_b32_dpp v21, v16, v13 row_newbcast:10 row_mask:0xf bank_mask:0xf
    v_and_b32_dpp v22, v16, v14 row_newbcast:10 row_mask:0xf bank_mask:0xf
    v_and_b32_dpp v23, v16, v15 row_newbcast:10 row_mask:0xf bank_mask:0xf
    s_waitcnt vmcnt(2)
    s_xor_b32 s59, s91, 729088
    buffer_load_dwordx4 v[124:127], v18, s[12:15], s59 offen
    v_mfma_f32_16x16x32_bf16 v[28:31], v[20:23], v[112:115], v[28:31]
    v_and_b32_dpp v24, v17, v12 row_newbcast:10 row_mask:0xf bank_mask:0xf
    v_and_b32_dpp v25, v17, v13 row_newbcast:10 row_mask:0xf bank_mask:0xf
    v_and_b32_dpp v26, v17, v14 row_newbcast:10 row_mask:0xf bank_mask:0xf
    v_and_b32_dpp v27, v17, v15 row_newbcast:10 row_mask:0xf bank_mask:0xf
    s_waitcnt vmcnt(2)
    s_xor_b32 s59, s91, 786432
    buffer_load_dwordx4 v[128:131], v18, s[12:15], s59 offen
    v_mfma_f32_16x16x32_bf16 v[28:31], v[24:27], v[116:119], v[28:31]
    v_and_b32_dpp v20, v16, v12 row_newbcast:11 row_mask:0xf bank_mask:0xf
    v_and_b32_dpp v21, v16, v13 row_newbcast:11 row_mask:0xf bank_mask:0xf
    v_and_b32_dpp v22, v16, v14 row_newbcast:11 row_mask:0xf bank_mask:0xf
    v_and_b32_dpp v23, v16, v15 row_newbcast:11 row_mask:0xf bank_mask:0xf
    s_waitcnt vmcnt(2)
    s_xor_b32 s59, s91, 794624
    buffer_load_dwordx4 v[132:135], v18, s[12:15], s59 offen
    v_mfma_f32_16x16x32_bf16 v[28:31], v[20:23], v[120:123], v[28:31]
    v_and_b32_dpp v24, v17, v12 row_newbcast:11 row_mask:0xf bank_mask:0xf
    v_and_b32_dpp v25, v17, v13 row_newbcast:11 row_mask:0xf bank_mask:0xf
    v_and_b32_dpp v26, v17, v14 row_newbcast:11 row_mask:0xf bank_mask:0xf
    v_and_b32_dpp v27, v17, v15 row_newbcast:11 row_mask:0xf bank_mask:0xf
    s_waitcnt vmcnt(2)
    s_xor_b32 s59, s91, 851968
    buffer_load_dwordx4 v[136:139], v18, s[12:15], s59 offen
    v_mfma_f32_16x16x32_bf16 v[28:31], v[24:27], v[124:127], v[28:31]
    v_and_b32_dpp v20, v16, v12 row_newbcast:12 row_mask:0xf bank_mask:0xf
    v_and_b32_dpp v21, v16, v13 row_newbcast:12 row_mask:0xf bank_mask:0xf
    v_and_b32_dpp v22, v16, v14 row_newbcast:12 row_mask:0xf bank_mask:0xf
    v_and_b32_dpp v23, v16, v15 row_newbcast:12 row_mask:0xf bank_mask:0xf
    s_waitcnt vmcnt(2)
    s_xor_b32 s59, s91, 860160
    buffer_load_dwordx4 v[140:143], v18, s[12:15], s59 offen
    v_mfma_f32_16x16x32_bf16 v[28:31], v[20:23], v[128:131], v[28:31]
    v_and_b32_dpp v24, v17, v12 row_newbcast:12 row_mask:0xf bank_mask:0xf
    v_and_b32_dpp v25, v17, v13 row_newbcast:12 row_mask:0xf bank_mask:0xf
    v_and_b32_dpp v26, v17, v14 row_newbcast:12 row_mask:0xf bank_mask:0xf
    v_and_b32_dpp v27, v17, v15 row_newbcast:12 row_mask:0xf bank_mask:0xf
    s_waitcnt vmcnt(2)
    s_xor_b32 s59, s91, 917504
    buffer_load_dwordx4 v[144:147], v18, s[12:15], s59 offen
    v_mfma_f32_16x16x32_bf16 v[28:31], v[24:27], v[132:135], v[28:31]
    v_and_b32_dpp v20, v16, v12 row_newbcast:13 row_mask:0xf bank_mask:0xf
    v_and_b32_dpp v21, v16, v13 row_newbcast:13 row_mask:0xf bank_mask:0xf
    v_and_b32_dpp v22, v16, v14 row_newbcast:13 row_mask:0xf bank_mask:0xf
    v_and_b32_dpp v23, v16, v15 row_newbcast:13 row_mask:0xf bank_mask:0xf
    s_waitcnt vmcnt(2)
    s_xor_b32 s59, s91, 925696
    buffer_load_dwordx4 v[148:151], v18, s[12:15], s59 offen
    v_mfma_f32_16x16x32_bf16 v[28:31], v[20:23], v[136:139], v[28:31]
    v_and_b32_dpp v24, v17, v12 row_newbcast:13 row_mask:0xf bank_mask:0xf
    v_and_b32_dpp v25, v17, v13 row_newbcast:13 row_mask:0xf bank_mask:0xf
    v_and_b32_dpp v26, v17, v14 row_newbcast:13 row_mask:0xf bank_mask:0xf
    v_and_b32_dpp v27, v17, v15 row_newbcast:13 row_mask:0xf bank_mask:0xf
    s_waitcnt vmcnt(2)
    s_xor_b32 s59, s91, 983040
    buffer_load_dwordx4 v[152:155], v18, s[12:15], s59 offen
    v_mfma_f32_16x16x32_bf16 v[28:31], v[24:27], v[140:143], v[28:31]
    v_and_b32_dpp v20, v16, v12 row_newbcast:14 row_mask:0xf bank_mask:0xf
    v_and_b32_dpp v21, v16, v13 row_newbcast:14 row_mask:0xf bank_mask:0xf
    v_and_b32_dpp v22, v16, v14 row_newbcast:14 row_mask:0xf bank_mask:0xf
    v_and_b32_dpp v23, v16, v15 row_newbcast:14 row_mask:0xf bank_mask:0xf
    s_waitcnt vmcnt(2)
    s_xor_b32 s59, s91, 991232
    buffer_load_dwordx4 v[156:159], v18, s[12:15], s59 offen
    v_mfma_f32_16x16x32_bf16 v[28:31], v[20:23], v[144:147], v[28:31]
    v_and_b32_dpp v24, v17, v12 row_newbcast:14 row_mask:0xf bank_mask:0xf
    v_and_b32_dpp v25, v17, v13 row_newbcast:14 row_mask:0xf bank_mask:0xf
    v_and_b32_dpp v26, v17, v14 row_newbcast:14 row_mask:0xf bank_mask:0xf
    v_and_b32_dpp v27, v17, v15 row_newbcast:14 row_mask:0xf bank_mask:0xf
    s_waitcnt vmcnt(2)
    s_nop 0
    v_mfma_f32_16x16x32_bf16 v[28:31], v[24:27], v[148:151], v[28:31]
    v_and_b32_dpp v20, v16, v12 row_newbcast:15 row_mask:0xf bank_mask:0xf
    v_and_b32_dpp v21, v16, v13 row_newbcast:15 row_mask:0xf bank_mask:0xf
    v_and_b32_dpp v22, v16, v14 row_newbcast:15 row_mask:0xf bank_mask:0xf
    v_and_b32_dpp v23, v16, v15 row_newbcast:15 row_mask:0xf bank_mask:0xf
    s_waitcnt vmcnt(1)
    s_nop 0
    v_mfma_f32_16x16x32_bf16 v[28:31], v[20:23], v[152:155], v[28:31]
    v_and_b32_dpp v24, v17, v12 row_newbcast:15 row_mask:0xf bank_mask:0xf
    v_and_b32_dpp v25, v17, v13 row_newbcast:15 row_mask:0xf bank_mask:0xf
    v_and_b32_dpp v26, v17, v14 row_newbcast:15 row_mask:0xf bank_mask:0xf
    v_and_b32_dpp v27, v17, v15 row_newbcast:15 row_mask:0xf bank_mask:0xf
    s_waitcnt vmcnt(0)
    s_nop 0
    v_mfma_f32_16x16x32_bf16 v[28:31], v[24:27], v[156:159], v[28:31]
    v_mov_b32 v18, 156672
    s_nop 6
    ds_write_b128 v3, v[28:31]
    s_mov_b64 exec, 1
    ds_add_u32 v18, v19
    s_mov_b64 exec, -1
    s_mov_b32 s16, s44
    s_and_b32 s17, s45, 0xffff
    s_mov_b32 s18, 0x400000
    s_mov_b32 s19, 0x20000
    s_mov_b32 s20, s48
    s_and_b32 s21, s49, 0xffff
    s_mov_b32 s22, 0x1c0000
    s_mov_b32 s23, 0x20000
    s_mov_b32 s24, s50
    s_and_b32 s25, s51, 0xffff
    s_mov_b32 s26, 0x1c0000
    s_mov_b32 s27, 0x20000
    s_mov_b32 s28, s56
    s_and_b32 s29, s57, 0xffff
    s_mov_b32 s30, 0x84000
    s_mov_b32 s31, 0x20000
    v_mov_b32 v3, 155904
L_poll7:
    s_sub_u32 s7, s7, 1
    s_cbranch_scc1 L_end
    s_sleep 16
    ds_read_b32 v1, v3
    s_waitcnt lgkmcnt(0)
    v_readfirstlane_b32 s6, v1
    s_cmp_ge_i32 s6, 52
    s_cbranch_scc0 L_poll7
L_go6:
    v_mov_b64 v[28:29], 0
    v_mov_b64 v[30:31], 0
    s_and_b32 s88, s5, 7
    s_lshl_b32 s88, s88, 2
    s_lshr_b32 s6, s5, 3
    s_add_u32 s88, s88, s6
    s_cmp_ge_u32 s88, 28
    s_cbranch_scc1 L_ffn_done
    v_bfe_u32 v1, v0, 3, 1
    v_lshl_add_u32 v1, v9, 7, v1
    s_lshl_b32 s6, s33, 1
    v_add_u32 v1, s6, v1
    v_mul_u32_u24 v1, 3584, v1
    v_and_b32 v2, 7, v0
    v_lshl_add_u32 v1, v2, 4, v1
    s_lshl_b32 s6, s88, 7
    v_add_u32 v1, s6, v1
    s_xor_b32 s6, s90, 0
    s_mulk_i32 s6, 28672
    s_waitcnt vmcnt(0)
    buffer_load_dwordx4 v[32:35], v1, s[20:23], s6 offen
    s_xor_b32 s6, s90, 1
    s_mulk_i32 s6, 28672
    s_waitcnt vmcnt(0)
    buffer_load_dwordx4 v[36:39], v1, s[20:23], s6 offen
    s_xor_b32 s6, s90, 2
    s_mulk_i32 s6, 28672
    s_waitcnt vmcnt(0)
    buffer_load_dwordx4 v[40:43], v1, s[20:23], s6 offen
    s_xor_b32 s6, s90, 3
    s_mulk_i32 s6, 28672
    s_waitcnt vmcnt(0)
    buffer_load_dwordx4 v[44:47], v1, s[20:23], s6 offen
    s_xor_b32 s6, s90, 4
    s_mulk_i32 s6, 28672
    s_waitcnt vmcnt(0)
    buffer_load_dwordx4 v[48:51], v1, s[20:23], s6 offen
    s_xor_b32 s6, s90, 5
    s_mulk_i32 s6, 28672
    s_waitcnt vmcnt(0)
    buffer_load_dwordx4 v[52:55], v1, s[20:23], s6 offen
    s_xor_b32 s6, s90, 6
    s_mulk_i32 s6, 28672
    s_waitcnt vmcnt(0)
    buffer_load_dwordx4 v[56:59], v1, s[20:23], s6 offen
    s_xor_b32 s6, s90, 7
    s_mulk_i32 s6, 28672
    s_waitcnt vmcnt(0)
    buffer_load_dwordx4 v[60:63], v1, s[20:23], s6 offen
    s_xor_b32 s6, s90, 8
    s_mulk_i32 s6, 28672
    s_waitcnt vmcnt(0)
    buffer_load_dwordx4 v[64:67], v1, s[20:23], s6 offen
    s_xor_b32 s6, s90, 9
    s_mulk_i32 s6, 28672
    s_waitcnt vmcnt(0)
    buffer_load_dwordx4 v[68:71], v1, s[20:23], s6 offen
    s_xor_b32 s6, s90, 10
    s_mulk_i32 s6, 28672
    s_waitcnt vmcnt(0)
    buffer_load_dwordx4 v[72:75], v1, s[20:23], s6 offen
    s_xor_b32 s6, s90, 11
    s_mulk_i32 s6, 28672
    s_waitcnt vmcnt(0)
    buffer_load_dwordx4 v[76:79], v1, s[20:23], s6 offen
    s_xor_b32 s6, s90, 12
    s_mulk_i32 s6, 28672
    s_waitcnt vmcnt(0)
    buffer_load_dwordx4 v[80:83], v1, s[20:23], s6 offen
    s_xor_b32 s6, s90, 13
    s_mulk_i32 s6, 28672
    s_waitcnt vmcnt(0)
    buffer_load_dwordx4 v[84:87], v1, s[20:23], s6 offen
    s_xor_b32 s6, s90, 14
    s_mulk_i32 s6, 28672
    s_waitcnt vmcnt(0)
    buffer_load_dwordx4 v[88:91], v1, s[20:23], s6 offen
    s_xor_b32 s6, s90, 15
    s_mulk_i32 s6, 28672
    s_waitcnt vmcnt(0)
    buffer_load_dwordx4 v[92:95], v1, s[20:23], s6 offen
    v_lshlrev_b32 v1, 14, v9
    v_lshl_add_u32 v1, v10, 4, v1
    s_lshl_b32 s6, s88, 16
    s_lshl_b32 s35, s33, 8
    s_add_u32 s6, s6, s35
    v_add_u32 v1, s6, v1
    s_lshl_b32 s91, s90, 10
    s_xor_b32 s6, s91, 0
    s_waitcnt vmcnt(0)
    buffer_load_dwordx4 v[96:99], v1, s[24:27], s6 offen offset:0
    s_waitcnt vmcnt(0)
    buffer_load_dwordx4 v[100:103], v1, s[24:27], s6 offen offset:1024
    s_xor_b32 s6, s91, 2048
    s_waitcnt vmcnt(0)
    buffer_load_dwordx4 v[104:107], v1, s[24:27], s6 offen offset:0
    s_waitcnt vmcnt(0)
    buffer_load_dwordx4 v[108:111], v1, s[24:27], s6 offen offset:1024
    s_xor_b32 s6, s91, 4096
    s_waitcnt vmcnt(0)
    buffer_load_dwordx4 v[112:115], v1, s[24:27], s6 offen offset:0
    s_waitcnt vmcnt(0)
    buffer_load_dwordx4 v[116:119], v1, s[24:27], s6 offen offset:1024
    s_xor_b32 s6, s91, 6144
    s_waitcnt vmcnt(0)
    buffer_load_dwordx4 v[120:123], v1, s[24:27], s6 offen offset:0
    s_waitcnt vmcnt(0)
    buffer_load_dwordx4 v[124:127], v1, s[24:27], s6 offen offset:1024
    s_xor_b32 s6, s91, 8192
    s_waitcnt vmcnt(0)
    buffer_load_dwordx4 v[128:131], v1, s[24:27], s6 offen offset:0
    s_waitcnt vmcnt(0)
    buffer_load_dwordx4 v[132:135], v1, s[24:27], s6 offen offset:1024
    s_xor_b32 s6, s91, 10240
    s_waitcnt vmcnt(0)
    buffer_load_dwordx4 v[136:139], v1, s[24:27], s6 offen offset:0
    s_waitcnt vmcnt(0)
    buffer_load_dwordx4 v[140:143], v1, s[24:27], s6 offen offset:1024
    s_xor_b32 s6, s91, 12288
    s_waitcnt vmcnt(0)
    buffer_load_dwordx4 v[144:147], v1, s[24:27], s6 offen offset:0
    s_waitcnt vmcnt(0)
    buffer_load_dwordx4 v[148:151], v1, s[24:27], s6 offen offset:1024
    s_xor_b32 s6, s91, 14336
    s_waitcnt vmcnt(0)
    buffer_load_dwordx4 v[152:155], v1, s[24:27], s6 offen offset:0
    s_waitcnt vmcnt(0)
    buffer_load_dwordx4 v[156:159], v1, s[24:27], s6 offen offset:1024
    v_mov_b32_dpp v1, v16 row_newbcast:0 row_mask:0xf bank_mask:0x3
    v_mov_b32_dpp v1, v17 row_newbcast:0 row_mask:0xf bank_mask:0xc
    v_and_b32 v20, v1, v12
    v_and_b32 v21, v1, v13
    v_and_b32 v22, v1, v14
    v_and_b32 v23, v1, v15
    s_nop 1
    v_mfma_f32_16x16x32_bf16 v[28:31], v[20:23], v[32:35], v[28:31]
    v_mov_b32_dpp v1, v16 row_newbcast:1 row_mask:0xf bank_mask:0x3
    v_mov_b32_dpp v1, v17 row_newbcast:1 row_mask:0xf bank_mask:0xc
    v_and_b32 v24, v1, v12
    v_and_b32 v25, v1, v13
    v_and_b32 v26, v1, v14
    v_and_b32 v27, v1, v15
    s_nop 1
    v_mfma_f32_16x16x32_bf16 v[28:31], v[24:27], v[36:39], v[28:31]
    v_mov_b32_dpp v1, v16 row_newbcast:2 row_mask:0xf bank_mask:0x3
    v_mov_b32_dpp v1, v17 row_newbcast:2 row_mask:0xf bank_mask:0xc
    v_and_b32 v20, v1, v12
    v_and_b32 v21, v1, v13
    v_and_b32 v22, v1, v14
    v_and_b32 v23, v1, v15
    s_nop 1
    v_mfma_f32_16x16x32_bf16 v[28:31], v[20:23], v[40:43], v[28:31]
    v_mov_b32_dpp v1, v16 row_newbcast:3 row_mask:0xf bank_mask:0x3
    v_mov_b32_dpp v1, v17 row_newbcast:3 row_mask:0xf bank_mask:0xc
    v_and_b32 v24, v1, v12
    v_and_b32 v25, v1, v13
    v_and_b32 v26, v1, v14
    v_and_b32 v27, v1, v15
    s_nop 1
    v_mfma_f32_16x16x32_bf16 v[28:31], v[24:27], v[44:47], v[28:31]
    v_mov_b32_dpp v1, v16 row_newbcast:4 row_mask:0xf bank_mask:0x3
    v_mov_b32_dpp v1, v17 row_newbcast:4 row_mask:0xf bank_mask:0xc
    v_and_b32 v20, v1, v12
    v_and_b32 v21, v1, v13
    v_and_b32 v22, v1, v14
    v_and_b32 v23, v1, v15
    s_nop 1
    v_mfma_f32_16x16x32_bf16 v[28:31], v[20:23], v[48:51], v[28:31]
    v_mov_b32_dpp v1, v16 row_newbcast:5 row_mask:0xf bank_mask:0x3
    v_mov_b32_dpp v1, v17 row_newbcast:5 row_mask:0xf bank_mask:0xc
    v_and_b32 v24, v1, v12
    v_and_b32 v25, v1, v13
    v_and_b32 v26, v1, v14
    v_and_b32 v27, v1, v15
    s_nop 1
    v_mfma_f32_16x16x32_bf16 v[28:31], v[24:27], v[52:55], v[28:31]
    v_mov_b32_dpp v1, v16 row_newbcast:6 row_mask:0xf bank_mask:0x3
    v_mov_b32_dpp v1, v17 row_newbcast:6 row_mask:0xf bank_mask:0xc
    v_and_b32 v20, v1, v12
    v_and_b32 v21, v1, v13
    v_and_b32 v22, v1, v14
    v_and_b32 v23, v1, v15
    s_nop 1
    v_mfma_f32_16x16x32_bf16 v[28:31], v[20:23], v[56:59], v[28:31]
    v_mov_b32_dpp v1, v16 row_newbcast:7 row_mask:0xf bank_mask:0x3
    v_mov_b32_dpp v1, v17 row_newbcast:7 row_mask:0xf bank_mask:0xc
    v_and_b32 v24, v1, v12
    v_and_b32 v25, v1, v13
    v_and_b32 v26, v1, v14
    v_and_b32 v27, v1, v15
    s_nop 1
    v_mfma_f32_16x16x32_bf16 v[28:31], v[24:27], v[60:63], v[28:31]
    v_mov_b32_dpp v1, v16 row_newbcast:8 row_mask:0xf bank_mask:0x3
    v_mov_b32_dpp v1, v17 row_newbcast:8 row_mask:0xf bank_mask:0xc
    v_and_b32 v20, v1, v12
    v_and_b32 v21, v1, v13
    v_and_b32 v22, v1, v14
    v_and_b32 v23, v1, v15
    s_nop 1
    v_mfma_f32_16x16x32_bf16 v[28:31], v[20:23], v[64:67], v[28:31]
    v_mov_b32_dpp v1, v16 row_newbcast:9 row_mask:0xf bank_mask:0x3
    v_mov_b32_dpp v1, v17 row_newbcast:9 row_mask:0xf bank_mask:0xc
    v_and_b32 v24, v1, v12
    v_and_b32 v25, v1, v13
    v_and_b32 v26, v1, v14
    v_and_b32 v27, v1, v15
    s_nop 1
    v_mfma_f32_16x16x32_bf16 v[28:31], v[24:27], v[68:71], v[28:31]
    v_mov_b32_dpp v1, v16 row_newbcast:10 row_mask:0xf bank_mask:0x3
    v_mov_b32_dpp v1, v17 row_newbcast:10 row_mask:0xf bank_mask:0xc
    v_and_b32 v20, v1, v12
    v_and_b32 v21, v1, v13
    v_and_b32 v22, v1, v14
    v_and_b32 v23, v1, v15
    s_nop 1
    v_mfma_f32_16x16x32_bf16 v[28:31], v[20:23], v[72:75], v[28:31]
    v_mov_b32_dpp v1, v16 row_newbcast:11 row_mask:0xf bank_mask:0x3
    v_mov_b32_dpp v1, v17 row_newbcast:11 row_mask:0xf bank_mask:0xc
    v_and_b32 v24, v1, v12
    v_and_b32 v25, v1, v13
    v_and_b32 v26, v1, v14
    v_and_b32 v27, v1, v15
    s_nop 1
    v_mfma_f32_16x16x32_bf16 v[28:31], v[24:27], v[76:79], v[28:31]
    v_mov_b32_dpp v1, v16 row_newbcast:12 row_mask:0xf bank_mask:0x3
    v_mov_b32_dpp v1, v17 row_newbcast:12 row_mask:0xf bank_mask:0xc
    v_and_b32 v20, v1, v12
    v_and_b32 v21, v1, v13
    v_and_b32 v22, v1, v14
    v_and_b32 v23, v1, v15
    s_nop 1
    v_mfma_f32_16x16x32_bf16 v[28:31], v[20:23], v[80:83], v[28:31]
    v_mov_b32_dpp v1, v16 row_newbcast:13 row_mask:0xf bank_mask:0x3
    v_mov_b32_dpp v1, v17 row_newbcast:13 row_mask:0xf bank_mask:0xc
    v_and_b32 v24, v1, v12
    v_and_b32 v25, v1, v13
    v_and_b32 v26, v1, v14
    v_and_b32 v27, v1, v15
    s_nop 1
    v_mfma_f32_16x16x32_bf16 v[28:31], v[24:27], v[84:87], v[28:31]
    v_mov_b32_dpp v1, v16 row_newbcast:14 row_mask:0xf bank_mask:0x3
    v_mov_b32_dpp v1, v17 row_newbcast:14 row_mask:0xf bank_mask:0xc
    v_and_b32 v20, v1, v12
    v_and_b32 v21, v1, v13
    v_and_b32 v22, v1, v14
    v_and_b32 v23, v1, v15
    s_nop 1
    v_mfma_f32_16x16x32_bf16 v[28:31], v[20:23], v[88:91], v[28:31]
    v_mov_b32_dpp v1, v16 row_newbcast:15 row_mask:0xf bank_mask:0x3
    v_mov_b32_dpp v1, v17 row_newbcast:15 row_mask:0xf bank_mask:0xc
    v_and_b32 v24, v1, v12
    v_and_b32 v25, v1, v13
    v_and_b32 v26, v1, v14
    v_and_b32 v27, v1, v15
    s_nop 1
    v_mfma_f32_16x16x32_bf16 v[28:31], v[24:27], v[92:95], v[28:31]
    v_and_b32 v1, 7, v0
    v_lshlrev_b32 v1, 5, v1
    v_and_b32 v2, 16, v0
    v_add_u32 v1, v1, v2
    v_and_b32 v2, 8, v0
    v_lshl_add_u32 v1, v2, 5, v1
    s_lshl_b32 s6, s33, 9
    s_add_u32 s6, s6, 159488
    v_add_u32 v1, s6, v1
    s_mov_b32 exec_lo, 0x00ff00ff
    s_mov_b32 exec_hi, 0xff00ff00
    ds_write_b128 v1, v[28:31]
    s_mov_b64 exec, 1
    ds_add_u32 v18, v19 offset:4
    s_mov_b64 exec, -1
    v_add_u32 v2, 4, v18
L_poll9:
    s_sub_u32 s7, s7, 1
    s_cbranch_scc1 L_end
    s_sleep 1
    ds_read_b32 v1, v2
    s_waitcnt lgkmcnt(0)
    v_readfirstlane_b32 s6, v1
    s_cmp_ge_i32 s6, 4
    s_cbranch_scc0 L_poll9
L_go8:
    v_xor_b32 v1, s90, v0
    v_lshlrev_b32 v1, 2, v1
    v_add_u32 v1, 159488, v1
    ds_read2st64_b32 v[20:21], v1 offset0:0 offset1:1
    ds_read2st64_b32 v[22:23], v1 offset0:2 offset1:3
    ds_read2st64_b32 v[24:25], v1 offset0:4 offset1:5
    ds_read2st64_b32 v[26:27], v1 offset0:6 offset1:7
    s_waitcnt lgkmcnt(0)
    v_add_f32 v20, v20, v21
    v_add_f32 v22, v22, v23
    v_add_f32 v24, v24, v25
    v_add_f32 v26, v26, v27
    v_add_f32 v20, v20, v22
    v_add_f32 v24, v24, v26
    v_add_f32 v20, v20, v24
    v_cvt_pk_bf16_f32 v1, v20, v20
    v_and_b32 v1, 0xffff0000, v1
    v_mul_f32 v2, 0xbfb8aa3b, v1
    v_exp_f32 v2, v2
    s_nop 0
    v_add_f32 v2, 1.0, v2
    v_rcp_f32 v2, v2
    s_nop 0
    v_mul_f32 v1, v1, v2
    v_cvt_pk_bf16_f32 v16, v1, v1
    s_waitcnt vmcnt(0)
    s_nop 0
    v_and_b32_dpp v20, v16, v12 row_newbcast:0 row_mask:0xf bank_mask:0xf
    v_and_b32_dpp v21, v16, v13 row_newbcast:0 row_mask:0xf bank_mask:0xf
    v_and_b32_dpp v22, v16, v14 row_newbcast:0 row_mask:0xf bank_mask:0xf
    v_and_b32_dpp v23, v16, v15 row_newbcast:0 row_mask:0xf bank_mask:0xf
    s_nop 1
    v_mfma_f32_16x16x32_bf16 v[28:31], v[20:23], v[96:99], 0
    v_and_b32_dpp v24, v16, v12 row_newbcast:1 row_mask:0xf bank_mask:0xf
    v_and_b32_dpp v25, v16, v13 row_newbcast:1 row_mask:0xf bank_mask:0xf
    v_and_b32_dpp v26, v16, v14 row_newbcast:1 row_mask:0xf bank_mask:0xf
    v_and_b32_dpp v27, v16, v15 row_newbcast:1 row_mask:0xf bank_mask:0xf
    s_nop 1
    v_mfma_f32_16x16x32_bf16 v[28:31], v[24:27], v[100:103], v[28:31]
    v_and_b32_dpp v20, v16, v12 row_newbcast:2 row_mask:0xf bank_mask:0xf
    v_and_b32_dpp v21, v16, v13 row_newbcast:2 row_mask:0xf bank_mask:0xf
    v_and_b32_dpp v22, v16, v14 row_newbcast:2 row_mask:0xf bank_mask:0xf
    v_and_b32_dpp v23, v16, v15 row_newbcast:2 row_mask:0xf bank_mask:0xf
    s_nop 1
    v_mfma_f32_16x16x32_bf16 v[28:31], v[20:23], v[104:107], v[28:31]
    v_and_b32_dpp v24, v16, v12 row_newbcast:3 row_mask:0xf bank_mask:0xf
    v_and_b32_dpp v25, v16, v13 row_newbcast:3 row_mask:0xf bank_mask:0xf
    v_and_b32_dpp v26, v16, v14 row_newbcast:3 row_mask:0xf bank_mask:0xf
    v_and_b32_dpp v27, v16, v15 row_newbcast:3 row_mask:0xf bank_mask:0xf
    s_nop 1
    v_mfma_f32_16x16x32_bf16 v[28:31], v[24:27], v[108:111], v[28:31]
    v_and_b32_dpp v20, v16, v12 row_newbcast:4 row_mask:0xf bank_mask:0xf
    v_and_b32_dpp v21, v16, v13 row_newbcast:4 row_mask:0xf bank_mask:0xf
    v_and_b32_dpp v22, v16, v14 row_newbcast:4 row_mask:0xf bank_mask:0xf
    v_and_b32_dpp v23, v16, v15 row_newbcast:4 row_mask:0xf bank_mask:0xf
    s_nop 1
    v_mfma_f32_16x16x32_bf16 v[28:31], v[20:23], v[112:115], v[28:31]
    v_and_b32_dpp v24, v16, v12 row_newbcast:5 row_mask:0xf bank_mask:0xf
    v_and_b32_dpp v25, v16, v13 row_newbcast:5 row_mask:0xf bank_mask:0xf
    v_and_b32_dpp v26, v16, v14 row_newbcast:5 row_mask:0xf bank_mask:0xf
    v_and_b32_dpp v27, v16, v15 row_newbcast:5 row_mask:0xf bank_mask:0xf
    s_nop 1
    v_mfma_f32_16x16x32_bf16 v[28:31], v[24:27], v[116:119], v[28:31]
    v_and_b32_dpp v20, v16, v12 row_newbcast:6 row_mask:0xf bank_mask:0xf
    v_and_b32_dpp v21, v16, v13 row_newbcast:6 row_mask:0xf bank_mask:0xf
    v_and_b32_dpp v22, v16, v14 row_newbcast:6 row_mask:0xf bank_mask:0xf
    v_and_b32_dpp v23, v16, v15 row_newbcast:6 row_mask:0xf bank_mask:0xf
    s_nop 1
    v_mfma_f32_16x16x32_bf16 v[28:31], v[20:23], v[120:123], v[28:31]
    v_and_b32_dpp v24, v16, v12 row_newbcast:7 row_mask:0xf bank_mask:0xf
    v_and_b32_dpp v25, v16, v13 row_newbcast:7 row_mask:0xf bank_mask:0xf
    v_and_b32_dpp v26, v16, v14 row_newbcast:7 row_mask:0xf bank_mask:0xf
    v_and_b32_dpp v27, v16, v15 row_newbcast:7 row_mask:0xf bank_mask:0xf
    s_nop 1
    v_mfma_f32_16x16x32_bf16 v[28:31], v[24:27], v[124:127], v[28:31]
    v_and_b32_dpp v20, v16, v12 row_newbcast:8 row_mask:0xf bank_mask:0xf
    v_and_b32_dpp v21, v16, v13 row_newbcast:8 row_mask:0xf bank_mask:0xf
    v_and_b32_dpp v22, v16, v14 row_newbcast:8 row_mask:0xf bank_mask:0xf
    v_and_b32_dpp v23, v16, v15 row_newbcast:8 row_mask:0xf bank_mask:0xf
    s_nop 1
    v_mfma_f32_16x16x32_bf16 v[28:31], v[20:23], v[128:131], v[28:31]
    v_and_b32_dpp v24, v16, v12 row_newbcast:9 row_mask:0xf bank_mask:0xf
    v_and_b32_dpp v25, v16, v13 row_newbcast:9 row_mask:0xf bank_mask:0xf
    v_and_b32_dpp v26, v16, v14 row_newbcast:9 row_mask:0xf bank_mask:0xf
    v_and_b32_dpp v27, v16, v15 row_newbcast:9 row_mask:0xf bank_mask:0xf
    s_nop 1
    v_mfma_f32_16x16x32_bf16 v[28:31], v[24:27], v[132:135], v[28:31]
    v_and_b32_dpp v20, v16, v12 row_newbcast:10 row_mask:0xf bank_mask:0xf
    v_and_b32_dpp v21, v16, v13 row_newbcast:10 row_mask:0xf bank_mask:0xf
    v_and_b32_dpp v22, v16, v14 row_newbcast:10 row_mask:0xf bank_mask:0xf
    v_and_b32_dpp v23, v16, v15 row_newbcast:10 row_mask:0xf bank_mask:0xf
    s_nop 1
    v_mfma_f32_16x16x32_bf16 v[28:31], v[20:23], v[136:139], v[28:31]
    v_and_b32_dpp v24, v16, v12 row_newbcast:11 row_mask:0xf bank_mask:0xf
    v_and_b32_dpp v25, v16, v13 row_newbcast:11 row_mask:0xf bank_mask:0xf
    v_and_b32_dpp v26, v16, v14 row_newbcast:11 row_mask:0xf bank_mask:0xf
    v_and_b32_dpp v27, v16, v15 row_newbcast:11 row_mask:0xf bank_mask:0xf
    s_nop 1
    v_mfma_f32_16x16x32_bf16 v[28:31], v[24:27], v[140:143], v[28:31]
    v_and_b32_dpp v20, v16, v12 row_newbcast:12 row_mask:0xf bank_mask:0xf
    v_and_b32_dpp v21, v16, v13 row_newbcast:12 row_mask:0xf bank_mask:0xf
    v_and_b32_dpp v22, v16, v14 row_newbcast:12 row_mask:0xf bank_mask:0xf
    v_and_b32_dpp v23, v16, v15 row_newbcast:12 row_mask:0xf bank_mask:0xf
    s_nop 1
    v_mfma_f32_16x16x32_bf16 v[28:31], v[20:23], v[144:147], v[28:31]
    v_and_b32_dpp v24, v16, v12 row_newbcast:13 row_mask:0xf bank_mask:0xf
    v_and_b32_dpp v25, v16, v13 row_newbcast:13 row_mask:0xf bank_mask:0xf
    v_and_b32_dpp v26, v16, v14 row_newbcast:13 row_mask:0xf bank_mask:0xf
    v_and_b32_dpp v27, v16, v15 row_newbcast:13 row_mask:0xf bank_mask:0xf
    s_nop 1
    v_mfma_f32_16x16x32_bf16 v[28:31], v[24:27], v[148:151], v[28:31]
    v_and_b32_dpp v20, v16, v12 row_newbcast:14 row_mask:0xf bank_mask:0xf
    v_and_b32_dpp v21, v16, v13 row_newbcast:14 row_mask:0xf bank_mask:0xf
    v_and_b32_dpp v22, v16, v14 row_newbcast:14 row_mask:0xf bank_mask:0xf
    v_and_b32_dpp v23, v16, v15 row_newbcast:14 row_mask:0xf bank_mask:0xf
    s_nop 1
    v_mfma_f32_16x16x32_bf16 v[28:31], v[20:23], v[152:155], v[28:31]
    v_and_b32_dpp v24, v16, v12 row_newbcast:15 row_mask:0xf bank_mask:0xf
    v_and_b32_dpp v25, v16, v13 row_newbcast:15 row_mask:0xf bank_mask:0xf
    v_and_b32_dpp v26, v16, v14 row_newbcast:15 row_mask:0xf bank_mask:0xf
    v_and_b32_dpp v27, v16, v15 row_newbcast:15 row_mask:0xf bank_mask:0xf
    s_nop 1
    v_mfma_f32_16x16x32_bf16 v[28:31], v[24:27], v[156:159], v[28:31]
    s_nop 7
L_ffn_done:
    v_mov_b64 v[160:161], 0
    v_mov_b64 v[162:163], 0
    v_mov_b64 v[164:165], 0
    v_mov_b64 v[166:167], 0
    v_mov_b64 v[168:169], 0
    v_mov_b64 v[170:171], 0
    v_mov_b64 v[172:173], 0
    v_mov_b64 v[174:175], 0
    v_mov_b64 v[176:177], 0
    v_mov_b64 v[178:179], 0
    v_mov_b64 v[180:181], 0
    v_mov_b64 v[182:183], 0
    v_mov_b64 v[184:185], 0
    v_mov_b64 v[186:187], 0
    v_mov_b64 v[188:189], 0
    v_mov_b64 v[190:191], 0
    v_mov_b32 v160, v28
    v_mov_b32 v164, v29
    v_mov_b32 v168, v30
    v_mov_b32 v172, v31
    v_mov_b32 v176, v28
    v_mov_b32 v180, v29
    v_mov_b32 v184, v30
    v_mov_b32 v188, v31
    s_lshl_b32 s6, s2, 11
    v_add_u32 v11, s6, v11
    v_lshlrev_b32 v1, 12, v9
    v_lshl_add_u32 v1, v10, 4, v1
    s_lshl_b32 s6, s5, 17
    s_lshl_b32 s35, s33, 8
    s_add_u32 s6, s6, s35
    v_add_u32 v1, s6, v1
    s_mov_b32 s86, 0x05040100
    s_mov_b32 s87, 0x07060302
    s_bfe_u32 s91, s2, 0x20005
    s_lshl_b32 s91, s91, 15
    s_lshr_b32 s35, s2, 7
    s_lshl_b32 s35, s35, 11
    s_or_b32 s91, s91, s35
    s_xor_b32 s6, s91, 0
    s_add_u32 s35, s6, 16384
    buffer_load_dwordx4 v[20:23], v1, s[16:19], s6 offen offset:0
    buffer_load_dwordx4 v[24:27], v1, s[16:19], s35 offen offset:0
    s_waitcnt vmcnt(0)
    v_perm_b32 v32, v24, v20, s86
    v_perm_b32 v40, v24, v20, s87
    v_perm_b32 v48, v25, v21, s86
    v_perm_b32 v56, v25, v21, s87
    v_perm_b32 v64, v26, v22, s86
    v_perm_b32 v72, v26, v22, s87
    v_perm_b32 v80, v27, v23, s86
    v_perm_b32 v88, v27, v23, s87
    buffer_load_dwordx4 v[20:23], v1, s[16:19], s6 offen offset:1024
    buffer_load_dwordx4 v[24:27], v1, s[16:19], s35 offen offset:1024
    s_waitcnt vmcnt(0)
    v_perm_b32 v33, v24, v20, s86
    v_perm_b32 v41, v24, v20, s87
    v_perm_b32 v49, v25, v21, s86
    v_perm_b32 v57, v25, v21, s87
    v_perm_b32 v65, v26, v22, s86
    v_perm_b32 v73, v26, v22, s87
    v_perm_b32 v81, v27, v23, s86
    v_perm_b32 v89, v27, v23, s87
    s_xor_b32 s6, s91, 2048
    s_add_u32 s35, s6, 16384
    buffer_load_dwordx4 v[20:23], v1, s[16:19], s6 offen offset:0
    buffer_load_dwordx4 v[24:27], v1, s[16:19], s35 offen offset:0
    s_waitcnt vmcnt(0)
    v_perm_b32 v34, v24, v20, s86
    v_perm_b32 v42, v24, v20, s87
    v_perm_b32 v50, v25, v21, s86
    v_perm_b32 v58, v25, v21, s87
    v_perm_b32 v66, v26, v22, s86
    v_perm_b32 v74, v26, v22, s87
    v_perm_b32 v82, v27, v23, s86
    v_perm_b32 v90, v27, v23, s87
    buffer_load_dwordx4 v[20:23], v1, s[16:19], s6 offen offset:1024
    buffer_load_dwordx4 v[24:27], v1, s[16:19], s35 offen offset:1024
    s_waitcnt vmcnt(0)
    v_perm_b32 v35, v24, v20, s86
    v_perm_b32 v43, v24, v20, s87
    v_perm_b32 v51, v25, v21, s86
    v_perm_b32 v59, v25, v21, s87
    v_perm_b32 v67, v26, v22, s86
    v_perm_b32 v75, v26, v22, s87
    v_perm_b32 v83, v27, v23, s86
    v_perm_b32 v91, v27, v23, s87
    s_xor_b32 s6, s91, 32768
    s_add_u32 s35, s6, 16384
    buffer_load_dwordx4 v[20:23], v1, s[16:19], s6 offen offset:0
    buffer_load_dwordx4 v[24:27], v1, s[16:19], s35 offen offset:0
    s_waitcnt vmcnt(0)
    v_perm_b32 v36, v24, v20, s86
    v_perm_b32 v44, v24, v20, s87
    v_perm_b32 v52, v25, v21, s86
    v_perm_b32 v60, v25, v21, s87
    v_perm_b32 v68, v26, v22, s86
    v_perm_b32 v76, v26, v22, s87
    v_perm_b32 v84, v27, v23, s86
    v_perm_b32 v92, v27, v23, s87
    buffer_load_dwordx4 v[20:23], v1, s[16:19], s6 offen offset:1024
    buffer_load_dwordx4 v[24:27], v1, s[16:19], s35 offen offset:1024
    s_waitcnt vmcnt(0)
    v_perm_b32 v37, v24, v20, s86
    v_perm_b32 v45, v24, v20, s87
    v_perm_b32 v53, v25, v21, s86
    v_perm_b32 v61, v25, v21, s87
    v_perm_b32 v69, v26, v22, s86
    v_perm_b32 v77, v26, v22, s87
    v_perm_b32 v85, v27, v23, s86
    v_perm_b32 v93, v27, v23, s87
    s_xor_b32 s6, s91, 34816
    s_add_u32 s35, s6, 16384
    buffer_load_dwordx4 v[20:23], v1, s[16:19], s6 offen offset:0
    buffer_load_dwordx4 v[24:27], v1, s[16:19], s35 offen offset:0
    s_waitcnt vmcnt(0)
    v_perm_b32 v38, v24, v20, s86
    v_perm_b32 v46, v24, v20, s87
    v_perm_b32 v54, v25, v21, s86
    v_perm_b32 v62, v25, v21, s87
    v_perm_b32 v70, v26, v22, s86
    v_perm_b32 v78, v26, v22, s87
    v_perm_b32 v86, v27, v23, s86
    v_perm_b32 v94, v27, v23, s87
    buffer_load_dwordx4 v[20:23], v1, s[16:19], s6 offen offset:1024
    buffer_load_dwordx4 v[24:27], v1, s[16:19], s35 offen offset:1024
    s_waitcnt vmcnt(0)
    v_perm_b32 v39, v24, v20, s86
    v_perm_b32 v47, v24, v20, s87
    v_perm_b32 v55, v25, v21, s86
    v_perm_b32 v63, v25, v21, s87
    v_perm_b32 v71, v26, v22, s86
    v_perm_b32 v79, v26, v22, s87
    v_perm_b32 v87, v27, v23, s86
    v_perm_b32 v95, v27, v23, s87
    s_xor_b32 s6, s91, 65536
    s_add_u32 s35, s6, 16384
    buffer_load_dwordx4 v[20:23], v1, s[16:19], s6 offen offset:0
    buffer_load_dwordx4 v[24:27], v1, s[16:19], s35 offen offset:0
    s_waitcnt vmcnt(0)
    v_perm_b32 v96, v24, v20, s86
    v_perm_b32 v104, v24, v20, s87
    v_perm_b32 v112, v25, v21, s86
    v_perm_b32 v120, v25, v21, s87
    v_perm_b32 v128, v26, v22, s86
    v_perm_b32 v136, v26, v22, s87
    v_perm_b32 v144, v27, v23, s86
    v_perm_b32 v152, v27, v23, s87
    buffer_load_dwordx4 v[20:23], v1, s[16:19], s6 offen offset:1024
    buffer_load_dwordx4 v[24:27], v1, s[16:19], s35 offen offset:1024
    s_waitcnt vmcnt(0)
    v_perm_b32 v97, v24, v20, s86
    v_perm_b32 v105, v24, v20, s87
    v_perm_b32 v113, v25, v21, s86
    v_perm_b32 v121, v25, v21, s87
    v_perm_b32 v129, v26, v22, s86
    v_perm_b32 v137, v26, v22, s87
    v_perm_b32 v145, v27, v23, s86
    v_perm_b32 v153, v27, v23, s87
    s_xor_b32 s6, s91, 67584
    s_add_u32 s35, s6, 16384
    buffer_load_dwordx4 v[20:23], v1, s[16:19], s6 offen offset:0
    buffer_load_dwordx4 v[24:27], v1, s[16:19], s35 offen offset:0
    s_waitcnt vmcnt(0)
    v_perm_b32 v98, v24, v20, s86
    v_perm_b32 v106, v24, v20, s87
    v_perm_b32 v114, v25, v21, s86
    v_perm_b32 v122, v25, v21, s87
    v_perm_b32 v130, v26, v22, s86
    v_perm_b32 v138, v26, v22, s87
    v_perm_b32 v146, v27, v23, s86
    v_perm_b32 v154, v27, v23, s87
    buffer_load_dwordx4 v[20:23], v1, s[16:19], s6 offen offset:1024
    buffer_load_dwordx4 v[24:27], v1, s[16:19], s35 offen offset:1024
    s_waitcnt vmcnt(0)
    v_perm_b32 v99, v24, v20, s86
    v_perm_b32 v107, v24, v20, s87
    v_perm_b32 v115, v25, v21, s86
    v_perm_b32 v123, v25, v21, s87
    v_perm_b32 v131, v26, v22, s86
    v_perm_b32 v139, v26, v22, s87
    v_perm_b32 v147, v27, v23, s86
    v_perm_b32 v155, v27, v23, s87
    s_xor_b32 s6, s91, 98304
    s_add_u32 s35, s6, 16384
    buffer_load_dwordx4 v[20:23], v1, s[16:19], s6 offen offset:0
    buffer_load_dwordx4 v[24:27], v1, s[16:19], s35 offen offset:0
    s_waitcnt vmcnt(0)
    v_perm_b32 v100, v24, v20, s86
    v_perm_b32 v108, v24, v20, s87
    v_perm_b32 v116, v25, v21, s86
    v_perm_b32 v124, v25, v21, s87
    v_perm_b32 v132, v26, v22, s86
    v_perm_b32 v140, v26, v22, s87
    v_perm_b32 v148, v27, v23, s86
    v_perm_b32 v156, v27, v23, s87
    buffer_load_dwordx4 v[20:23], v1, s[16:19], s6 offen offset:1024
    buffer_load_dwordx4 v[24:27], v1, s[16:19], s35 offen offset:1024
    s_waitcnt vmcnt(0)
    v_perm_b32 v101, v24, v20, s86
    v_perm_b32 v109, v24, v20, s87
    v_perm_b32 v117, v25, v21, s86
    v_perm_b32 v125, v25, v21, s87
    v_perm_b32 v133, v26, v22, s86
    v_perm_b32 v141, v26, v22, s87
    v_perm_b32 v149, v27, v23, s86
    v_perm_b32 v157, v27, v23, s87
    s_xor_b32 s6, s91, 100352
    s_add_u32 s35, s6, 16384
    buffer_load_dwordx4 v[20:23], v1, s[16:19], s6 offen offset:0
    buffer_load_dwordx4 v[24:27], v1, s[16:19], s35 offen offset:0
    s_waitcnt vmcnt(0)
    v_perm_b32 v102, v24, v20, s86
    v_perm_b32 v110, v24, v20, s87
    v_perm_b32 v118, v25, v21, s86
    v_perm_b32 v126, v25, v21, s87
    v_perm_b32 v134, v26, v22, s86
    v_perm_b32 v142, v26, v22, s87
    v_perm_b32 v150, v27, v23, s86
    v_perm_b32 v158, v27, v23, s87
    buffer_load_dwordx4 v[20:23], v1, s[16:19], s6 offen offset:1024
    buffer_load_dwordx4 v[24:27], v1, s[16:19], s35 offen offset:1024
    s_waitcnt vmcnt(0)
    v_perm_b32 v103, v24, v20, s86
    v_perm_b32 v111, v24, v20, s87
    v_perm_b32 v119, v25, v21, s86
    v_perm_b32 v127, v25, v21, s87
    v_perm_b32 v135, v26, v22, s86
    v_perm_b32 v143, v26, v22, s87
    v_perm_b32 v151, v27, v23, s86
    v_perm_b32 v159, v27, v23, s87
    v_and_b32 v1, 48, v0
    v_and_b32 v2, 1, v0
    v_cmp_eq_u32 vcc, 1, v2
    v_lshlrev_b32 v2, 4, v2
    v_lshl_add_u32 v1, v1, 1, v2
    v_add_u32 v1, 159232, v1
    v_mov_b32 v2, 0x44444444
    v_mov_b32 v3, 0xeeeeeeee
    v_cndmask_b32 v3, v2, v3, vcc
    .p2align 3
    s_barrier
    s_barrier
    ds_read_b128 v[12:15], v1
    ds_read_b128 v[16:19], v1 offset:128
    s_waitcnt lgkmcnt(1)
    v_smfmac_f32_16x16x64_bf16 v[160:163], v[12:15], v[32:39], v3
    s_waitcnt lgkmcnt(0)
    v_smfmac_f32_16x16x64_bf16 v[160:163], v[16:19], v[96:103], v3
    v_smfmac_f32_16x16x64_bf16 v[176:179], v[12:15], v[64:71], v3
    v_smfmac_f32_16x16x64_bf16 v[176:179], v[16:19], v[128:135], v3
    v_smfmac_f32_16x16x64_bf16 v[164:167], v[12:15], v[40:47], v3
    v_smfmac_f32_16x16x64_bf16 v[164:167], v[16:19], v[104:111], v3
    v_smfmac_f32_16x16x64_bf16 v[180:183], v[12:15], v[72:79], v3
    v_smfmac_f32_16x16x64_bf16 v[180:183], v[16:19], v[136:143], v3
    v_smfmac_f32_16x16x64_bf16 v[168:171], v[12:15], v[48:55], v3
    v_smfmac_f32_16x16x64_bf16 v[168:171], v[16:19], v[112:119], v3
    v_add_f32_dpp v28, v160, v161 quad_perm:[0,1,2,3] row_mask:0x1 bank_mask:0xf
    v_smfmac_f32_16x16x64_bf16 v[184:187], v[12:15], v[80:87], v3
    v_smfmac_f32_16x16x64_bf16 v[184:187], v[16:19], v[144:151], v3
    v_add_f32_dpp v28, v176, v177 quad_perm:[0,1,2,3] row_mask:0x2 bank_mask:0xf
    v_smfmac_f32_16x16x64_bf16 v[172:175], v[12:15], v[56:63], v3
    v_smfmac_f32_16x16x64_bf16 v[172:175], v[16:19], v[120:127], v3
    v_add_f32_dpp v29, v164, v165 quad_perm:[0,1,2,3] row_mask:0x1 bank_mask:0xf
    v_smfmac_f32_16x16x64_bf16 v[188:191], v[12:15], v[88:95], v3
    v_smfmac_f32_16x16x64_bf16 v[188:191], v[16:19], v[152:159], v3
    v_add_f32_dpp v29, v180, v181 quad_perm:[0,1,2,3] row_mask:0x2 bank_mask:0xf
    v_min_u32 v28, -2, v28
    v_min_u32 v29, -2, v29
    v_add_f32_dpp v30, v168, v169 quad_perm:[0,1,2,3] row_mask:0x1 bank_mask:0xf
    v_add_f32_dpp v30, v184, v185 quad_perm:[0,1,2,3] row_mask:0x2 bank_mask:0xf
    v_min_u32 v30, -2, v30
    v_add_f32_dpp v31, v172, v173 quad_perm:[0,1,2,3] row_mask:0x1 bank_mask:0xf
    s_mov_b32 exec_hi, 0
    v_add_f32_dpp v31, v188, v189 quad_perm:[0,1,2,3] row_mask:0x2 bank_mask:0xf
    v_min_u32 v31, -2, v31
    buffer_store_dwordx4 v[28:31], v11, s[28:31], 0 offen sc0 sc1
    s_waitcnt vmcnt(0)
    s_barrier
    s_endpgm
L_aux:
    s_lshr_b32 s4, s2, 5
    s_lshl_b32 s6, s2, 11
    v_lshlrev_b32 v1, 4, v0
    v_mov_b64 v[20:21], -1
    v_mov_b64 v[22:23], -1
    s_lshl_b32 s33, s4, 5
    v_mov_b32 v18, s33
    v_mov_b32 v19, 1
    s_waitcnt lgkmcnt(0)
    s_mov_b32 s28, s56
    s_and_b32 s29, s57, 0xffff
    s_mov_b32 s30, 0x84000
    s_mov_b32 s31, 0x20000
    s_mov_b32 s60, s54
    s_and_b32 s61, s55, 0xffff
    s_mov_b32 s62, 0x100
    s_mov_b32 s63, 0x20000
    buffer_store_dwordx4 v[20:23], v1, s[28:31], s6 offen sc0 sc1
    buffer_store_dwordx4 v[20:23], v1, s[28:31], s6 offen offset:1024 sc0 sc1
    s_cmp_ge_u32 s2, 128
    s_cbranch_scc1 L_no_pclear
    s_lshl_b32 s6, s2, 7
    s_add_u32 s6, s6, 0x80000
    v_mov_b64 v[24:25], 0
    v_mov_b64 v[26:27], 0
    s_mov_b64 exec, 0xff
    buffer_store_dwordx4 v[24:27], v1, s[28:31], s6 offen sc0 sc1
L_no_pclear:
    s_mov_b64 exec, 1
    s_waitcnt vmcnt(0)
    buffer_atomic_add v19, v18, s[60:63], 0 offen
    s_mov_b64 exec, -1
    s_bfe_u32 s6, s2, 0x20003
    s_and_b32 s5, s2, 7
    s_lshl_b32 s5, s5, 2
    s_or_b32 s5, s5, s6
    v_lshrrev_b32 v1, 2, v0
    v_lshlrev_b32 v1, 11, v1
    v_and_b32 v2, 3, v0
    v_lshl_add_u32 v1, v2, 4, v1
    s_lshl_b32 s6, s4, 16
    s_lshl_b32 s35, s5, 6
    s_add_u32 s6, s6, s35
    v_add_u32 v8, s6, v1
    v_lshlrev_b32 v2, 3, v2
    v_bfe_u32 v1, v0, 4, 1
    v_lshl_add_u32 v2, v1, 2, v2
    v_bfe_u32 v1, v0, 5, 1
    v_lshl_add_u32 v2, v1, 1, v2
    s_lshl_b32 s6, s4, 10
    s_lshl_b32 s35, s5, 5
    s_add_u32 s6, s6, s35
    v_add_u32 v10, s6, v2
    v_mov_b32 v16, 155904
    s_lshr_b32 s33, s2, 3
    s_mul_i32 s27, s33, 8
    s_lshr_b32 s27, s27, 5
    s_add_u32 s27, s27, 56
    v_and_b32 v15, 7, v0
    v_lshlrev_b32 v15, 5, v15
    s_mov_b32 s8, s36
    s_and_b32 s9, s37, 0xffff
    s_mov_b32 s10, 0x2000
    s_mov_b32 s11, 0x20000
    s_mov_b32 s12, s52
    s_and_b32 s13, s53, 0xffff
    s_mov_b32 s14, 0x2000
    s_mov_b32 s15, 0x20000
L_poll11:
    s_sub_u32 s7, s7, 1
    s_cbranch_scc1 L_end
    s_sleep 8
    ds_read_b32 v1, v16
    s_waitcnt lgkmcnt(0)
    v_readfirstlane_b32 s26, v1
    s_cmp_ge_i32 s26, s27
    s_cbranch_scc0 L_poll11
L_go10:
    buffer_load_ushort v11, v10, s[8:11], 0 offen
    buffer_load_dword v1, v15, s[60:63], 0 offen sc0 sc1
    s_mov_b32 s58, 0
    s_waitcnt vmcnt(0)
    v_cmp_gt_u32 vcc, 32, v1
    v_lshlrev_b32 v11, 16, v11
    s_cbranch_vccnz L_ctrl_done
    s_mov_b32 s58, 1
    s_getreg_b32 s6, hwreg(HW_REG_XCC_ID)
    s_and_b32 s34, s6, 7
    s_lshl_b32 s34, s34, 3
    s_and_b32 s35, s2, 7
    s_or_b32 s34, s34, s35
    s_lshl_b32 s34, s34, 7
    s_add_u32 s34, s34, 0x80000
    s_mov_b32 s46, 0x40cb3333
    s_and_b32 s6, s6, 1
    s_cselect_b32 s46, 0x40be6666, s46
    v_and_b32 v14, 31, v0
    v_lshlrev_b32 v14, 2, v14
    s_lshl_b32 s33, s33, 2
    v_mov_b32 v13, s33
    v_lshlrev_b32 v17, 2, v0
    v_add_u32 v17, 156416, v17
    v_mov_b32 v12, 0x82000
    s_mov_b32 s47, 0
    s_mov_b32 s48, 0
    s_mov_b32 s43, 0
    s_mov_b32 s49, 80
    s_mov_b32 s44, 14043
    s_cmp_eq_u32 s33, 0
    s_cselect_b32 s49, s49, 0x7fff
L_ctrl:
    s_add_u32 s27, s27, 8
L_poll13:
    s_sub_u32 s7, s7, 1
    s_cbranch_scc1 L_end
    s_sleep 2
    ds_read_b32 v1, v16
    s_waitcnt lgkmcnt(0)
    v_readfirstlane_b32 s26, v1
    s_cmp_ge_i32 s26, s27
    s_cbranch_scc0 L_poll13
L_go12:
    s_cmp_ge_i32 s26, 492
    s_cbranch_scc1 L_ctrl_done
    s_sub_u32 s6, s26, s27
    s_and_b32 s6, s6, -8
    s_add_u32 s27, s27, s6
    buffer_load_dword v2, v14, s[28:31], s34 offen
    s_mov_b64 exec, 1
    s_cmp_lt_i32 s27, s49
    s_cbranch_scc1 L_ctrl_post
    v_mov_b32 v3, 2
    buffer_atomic_add v3, v12, s[28:31], 0 offen sc0
    v_add_u32 v12, 0x100, v12
    s_add_u32 s49, s49, 32
    s_cmp_gt_i32 s49, 470
    s_cselect_b32 s49, 0x7fff, s49
    s_waitcnt vmcnt(0)
    v_readfirstlane_b32 s6, v3
    s_sub_i32 s6, s6, 7
    s_mul_i32 s35, s6, 655
    s_mul_i32 s6, s6, s44
    s_add_i32 s43, s43, s35
    s_add_i32 s6, s6, s43
    s_ashr_i32 s6, s6, 8
    s_lshl_b32 s48, s6, 16
    s_sub_i32 s44, s44, 390
L_ctrl_post:
    v_or_b32 v3, s48, v1
    buffer_store_dword v3, v13, s[28:31], s34 offen
    s_mov_b64 exec, -1
    v_cvt_f32_u32 v6, v1
    s_waitcnt vmcnt(1)
    v_readfirstlane_b32 s45, v2
    v_and_b32 v2, 0xffff, v2
    v_cmp_ne_u32 vcc, 0, v2
    s_bcnt1_i32_b64 s6, vcc
    s_ashr_i32 s45, s45, 16
    s_nop 1
    v_add_u32_dpp v2, v2, v2 row_ror:8 row_mask:0xf bank_mask:0xf
    s_nop 1
    v_add_u32_dpp v2, v2, v2 row_ror:4 row_mask:0xf bank_mask:0xf
    s_nop 1
    v_add_u32_dpp v2, v2, v2 row_ror:2 row_mask:0xf bank_mask:0xf
    s_nop 1
    v_add_u32_dpp v2, v2, v2 row_ror:1 row_mask:0xf bank_mask:0xf
    s_nop 1
    v_add_u32_dpp v2, v2, v2 row_bcast:15 row_mask:0xa bank_mask:0xf
    s_nop 1
    v_add_u32_dpp v2, v2, v2 row_bcast:31 row_mask:0xc bank_mask:0xf
    v_cvt_f32_u32 v4, s6
    v_readlane_b32 s35, v2, 63
    v_rcp_f32 v4, v4
    v_mov_b32 v7, s46
    s_cmp_lt_i32 s27, 290
    s_cselect_b32 s6, 102, 0
    s_add_i32 s45, s45, s6
    v_cvt_f32_u32 v5, s35
    v_fma_f32 v6, v5, v4, -v6
    v_cvt_f32_i32 v5, s45
    v_fmac_f32 v7, 0x3ee66666, v6
    v_fmac_f32 v7, 0x3b800000, v5
    v_max_f32 v7, 0, v7
    v_cvt_u32_f32 v7, v7
    v_min_u32 v7, 7, v7
    s_cmp_eq_u32 s47, 0
    s_mov_b32 s47, 1
    s_cbranch_scc1 L_ctrl
    ds_write_b32 v17, v7
    s_cmp_lt_i32 s27, 484
    s_cbranch_scc1 L_ctrl
L_ctrl_done:
    s_mov_b32 s44, 0x8000
    s_cmp_eq_u32 s58, 0
    .p2align 3
    s_barrier
    s_barrier
    s_barrier
    s_cbranch_scc1 L_wait_batch
L_gather:
L_gather_loop:
    buffer_load_dwordx4 v[32:35], v8, s[28:31], 0 offen sc0 sc1
    buffer_load_dwordx4 v[36:39], v8, s[28:31], s44 offen sc0 sc1
    s_sub_u32 s7, s7, 1
    s_cbranch_scc1 L_end
    s_waitcnt vmcnt(0)
    v_max3_u32 v1, v32, v33, v34
    v_max3_u32 v2, v35, v36, v37
    v_max3_u32 v1, v1, v38, v39
    v_add_f32 v28, v32, v36
    v_max_u32 v1, v1, v2
    v_add_f32 v29, v33, v37
    v_cmp_eq_u32 vcc, -1, v1
    v_add_f32 v30, v34, v38
    v_add_f32 v31, v35, v39
    s_and_b64 exec, exec, vcc
    s_cbranch_execnz L_gather_loop
L_gather_done:
    s_mov_b64 exec, -1
    v_permlane32_swap_b32 v28, v29
    v_permlane32_swap_b32 v30, v31
    v_add_f32 v28, v28, v29
    v_add_f32 v30, v30, v31
    s_nop 1
    v_permlane16_swap_b32 v28, v30
    v_add_f32 v28, v28, v30
    s_nop 1
    v_add_f32_dpp v28, v28, v28 row_ror:8 row_mask:0xf bank_mask:0xf
    v_add_f32 v29, v11, v28
    s_nop 0
    v_add_f32_dpp v29, v28, v29 row_ror:4 row_mask:0xf bank_mask:0xf
    v_cvt_pk_bf16_f32 v29, v29, v29
    s_mov_b32 exec_lo, 0x000f000f
    s_mov_b32 exec_hi, 0x000f000f
    buffer_store_short v29, v10, s[12:15], 0 offen
L_end:
    s_endpgm
L_wait_batch:
    s_sub_u32 s7, s7, 1
    s_cbranch_scc1 L_end
    buffer_load_dword v1, v18, s[60:63], 0 offen sc0 sc1
    s_waitcnt vmcnt(0)
    v_cmp_gt_u32 vcc, 32, v1
    s_cbranch_vccz L_gather
    s_sleep 32
    s_branch L_wait_batch
L_ld_top:
    s_add_u32 s25, s25, 0x4000
    s_cmp_eq_u32 s25, 0x24000
    s_cselect_b32 s25, 0, s25
    s_add_i32 s27, s27, 1
    s_add_i32 s28, s28, 4
    s_cmp_eq_u32 s28, s29
    s_cbranch_scc1 L_ld_event
L_ld_go:
    s_and_b32 s24, s28, 0x4
    s_lshl_b32 s24, s24, 10
    s_and_b32 s22, s28, 0x78
    s_lshl_b32 s22, s22, 13
    s_or_b32 s24, s24, s22
    s_and_b32 s22, s28, 0x80
    s_lshl_b32 s22, s22, 7
    s_or_b32 s24, s24, s22
    s_cmp_ge_i32 s26, s27
    s_cbranch_scc1 L_go1
L_poll2:
    s_sub_u32 s7, s7, 1
    s_cbranch_scc1 L_end
    ds_read_b32 v5, v3
    s_waitcnt lgkmcnt(0)
    v_readfirstlane_b32 s26, v5
    s_cmp_ge_i32 s26, s27
    s_cbranch_scc0 L_poll2
L_go1:
    s_cmp_ge_i32 s31, 4
    s_cbranch_scc1 L_ld_up3
    s_cmp_ge_i32 s31, 2
    s_cbranch_scc1 L_ld_up4
    s_cmp_ge_i32 s31, 1
    s_cbranch_scc1 L_ld_d1
    s_branch L_ld_d0
L_ld_up4:
    s_cmp_ge_i32 s31, 3
    s_cbranch_scc1 L_ld_d3
    s_branch L_ld_d2
L_ld_up3:
    s_cmp_ge_i32 s31, 6
    s_cbranch_scc1 L_ld_up5
    s_cmp_ge_i32 s31, 5
    s_cbranch_scc1 L_ld_d5
    s_branch L_ld_d4
L_ld_up5:
    s_cmp_ge_i32 s31, 7
    s_cbranch_scc1 L_ld_d7
    s_branch L_ld_d6
L_ld_event:
    s_cmp_lg_u32 s28, 48
    s_cbranch_scc1 L_ld_ev_v
    s_mov_b32 s8, s44
    s_and_b32 s9, s45, 0xffff
    s_mov_b32 s10, 0x400000
    s_mov_b32 s11, 0x20000
    s_mov_b32 s12, s50
    s_and_b32 s13, s51, 0xffff
    s_mov_b32 s14, 0x1c0000
    s_mov_b32 s15, 0x20000
    s_mov_b32 s60, s48
    s_and_b32 s61, s49, 0xffff
    s_mov_b32 s62, 0x1c0000
    s_mov_b32 s63, 0x20000
    v_lshlrev_b32 v8, 4, v0
    s_bfe_u32 s4, s2, 0x10005
    s_lshl_b32 s4, s4, 12
    s_bfe_u32 s5, s2, 0x10006
    s_lshl_b32 s5, s5, 14
    s_or_b32 s4, s4, s5
    s_lshr_b32 s5, s2, 7
    s_lshl_b32 s33, s5, 16
    s_or_b32 s33, s33, s4
    s_and_b32 s34, s2, 31
    s_lshl_b32 s34, s34, 17
    s_or_b32 s33, s33, s34
    s_or_b32 s34, s33, 0
    s_waitcnt vmcnt(25)
    buffer_load_dwordx4 v[32:35], v8, s[8:11], s34 offen offset:0
    s_waitcnt vmcnt(25)
    buffer_load_dwordx4 v[32:35], v8, s[8:11], s34 offen offset:1024
    s_waitcnt vmcnt(25)
    buffer_load_dwordx4 v[32:35], v8, s[8:11], s34 offen offset:2048
    s_waitcnt vmcnt(25)
    buffer_load_dwordx4 v[32:35], v8, s[8:11], s34 offen offset:3072
    s_or_b32 s34, s33, 8192
    s_waitcnt vmcnt(25)
    buffer_load_dwordx4 v[32:35], v8, s[8:11], s34 offen offset:0
    s_waitcnt vmcnt(25)
    buffer_load_dwordx4 v[32:35], v8, s[8:11], s34 offen offset:1024
    s_waitcnt vmcnt(25)
    buffer_load_dwordx4 v[32:35], v8, s[8:11], s34 offen offset:2048
    s_waitcnt vmcnt(25)
    buffer_load_dwordx4 v[32:35], v8, s[8:11], s34 offen offset:3072
    s_or_b32 s34, s33, 32768
    s_waitcnt vmcnt(25)
    buffer_load_dwordx4 v[32:35], v8, s[8:11], s34 offen offset:0
    s_waitcnt vmcnt(25)
    buffer_load_dwordx4 v[32:35], v8, s[8:11], s34 offen offset:1024
    s_waitcnt vmcnt(25)
    buffer_load_dwordx4 v[32:35], v8, s[8:11], s34 offen offset:2048
    s_waitcnt vmcnt(25)
    buffer_load_dwordx4 v[32:35], v8, s[8:11], s34 offen offset:3072
    s_or_b32 s34, s33, 40960
    s_waitcnt vmcnt(25)
    buffer_load_dwordx4 v[32:35], v8, s[8:11], s34 offen offset:0
    s_waitcnt vmcnt(25)
    buffer_load_dwordx4 v[32:35], v8, s[8:11], s34 offen offset:1024
    s_waitcnt vmcnt(25)
    buffer_load_dwordx4 v[32:35], v8, s[8:11], s34 offen offset:2048
    s_waitcnt vmcnt(25)
    buffer_load_dwordx4 v[32:35], v8, s[8:11], s34 offen offset:3072
    s_and_b32 s35, s2, 7
    s_cmp_eq_u32 s35, 7
    s_cbranch_scc1 L_pf_done
    s_lshl_b32 s5, s5, 15
    s_or_b32 s4, s4, s5
    s_lshl_b32 s5, s35, 18
    s_or_b32 s4, s4, s5
    s_bfe_u32 s5, s2, 0x20003
    s_lshl_b32 s5, s5, 16
    s_or_b32 s4, s4, s5
    s_or_b32 s34, s4, 0
    s_waitcnt vmcnt(25)
    buffer_load_dwordx4 v[32:35], v8, s[12:15], s34 offen offset:0
    s_waitcnt vmcnt(25)
    buffer_load_dwordx4 v[32:35], v8, s[12:15], s34 offen offset:1024
    s_waitcnt vmcnt(25)
    buffer_load_dwordx4 v[32:35], v8, s[12:15], s34 offen offset:2048
    s_waitcnt vmcnt(25)
    buffer_load_dwordx4 v[32:35], v8, s[12:15], s34 offen offset:3072
    s_or_b32 s34, s4, 8192
    s_waitcnt vmcnt(25)
    buffer_load_dwordx4 v[32:35], v8, s[12:15], s34 offen offset:0
    s_waitcnt vmcnt(25)
    buffer_load_dwordx4 v[32:35], v8, s[12:15], s34 offen offset:1024
    s_waitcnt vmcnt(25)
    buffer_load_dwordx4 v[32:35], v8, s[12:15], s34 offen offset:2048
    s_waitcnt vmcnt(25)
    buffer_load_dwordx4 v[32:35], v8, s[12:15], s34 offen offset:3072
    v_lshrrev_b32 v9, 5, v0
    v_mul_u32_u24 v9, 3072, v9
    v_add_u32 v9, v9, v8
    s_lshr_b32 s34, s2, 3
    s_mul_i32 s34, s34, 57344
    s_lshl_b32 s35, s35, 9
    s_add_u32 s34, s34, s35
    s_waitcnt vmcnt(25)
    buffer_load_dwordx4 v[32:35], v9, s[60:63], s34 offen offset:0
    s_add_u32 s34, s34, 7168
    s_waitcnt vmcnt(25)
    buffer_load_dwordx4 v[32:35], v9, s[60:63], s34 offen offset:0
    s_add_u32 s34, s34, 7168
    s_waitcnt vmcnt(25)
    buffer_load_dwordx4 v[32:35], v9, s[60:63], s34 offen offset:0
    s_add_u32 s34, s34, 7168
    s_waitcnt vmcnt(25)
    buffer_load_dwordx4 v[32:35], v9, s[60:63], s34 offen offset:0
    s_add_u32 s34, s34, 7168
    s_waitcnt vmcnt(25)
    buffer_load_dwordx4 v[32:35], v9, s[60:63], s34 offen offset:0
    s_add_u32 s34, s34, 7168
    s_waitcnt vmcnt(25)
    buffer_load_dwordx4 v[32:35], v9, s[60:63], s34 offen offset:0
    s_add_u32 s34, s34, 7168
    s_waitcnt vmcnt(25)
    buffer_load_dwordx4 v[32:35], v9, s[60:63], s34 offen offset:0
    s_add_u32 s34, s34, 7168
    s_waitcnt vmcnt(25)
    buffer_load_dwordx4 v[32:35], v9, s[60:63], s34 offen offset:0
L_pf_done:
    s_mov_b32 s29, 256
    s_branch L_ld_go
L_ld_ev_v:
    s_cmp_lg_u32 s28, 256
    s_cbranch_scc1 L_ld_ev_end
    v_lshrrev_b32 v17, 4, v0
    v_lshlrev_b32 v17, 5, v17
    v_xor_b32 v16, v16, v17
    v_xor_b32 v17, 0x80, v16
    v_mov_b32 v18, v16
    v_mov_b32 v19, v17
    v_mov_b32 v20, v16
    v_mov_b32 v21, v17
    v_mov_b32 v22, v16
    v_mov_b32 v23, v17
    v_mov_b32 v24, v16
    v_mov_b32 v25, v17
    v_mov_b32 v26, v16
    v_mov_b32 v27, v17
    v_mov_b32 v28, v16
    v_mov_b32 v29, v17
    v_mov_b32 v30, v16
    v_mov_b32 v31, v17
    s_add_u32 s16, s40, s6
    s_addc_u32 s17, s41, 0
    s_and_b32 s17, s17, 0xffff
    s_mov_b32 s29, 512
    s_branch L_ld_go
L_ld_ev_end:
    v_mov_b32 v4, 506
    s_waitcnt vmcnt(24)
    ds_write_b32 v2, v4
    v_mov_b32 v4, 507
    s_waitcnt vmcnt(20)
    ds_write_b32 v2, v4
    v_mov_b32 v4, 508
    s_waitcnt vmcnt(16)
    ds_write_b32 v2, v4
    v_mov_b32 v4, 509
    s_waitcnt vmcnt(12)
    ds_write_b32 v2, v4
    v_mov_b32 v4, 510
    s_waitcnt vmcnt(8)
    ds_write_b32 v2, v4
    v_mov_b32 v4, 511
    s_waitcnt vmcnt(4)
    ds_write_b32 v2, v4
    s_waitcnt vmcnt(0)
    s_barrier
    s_endpgm
.p2align 12
L_consumer:
    v_add_u32 v122, 0x100, v2
    s_setprio 2
    v_and_b32 v1, 15, v0
    v_lshrrev_b32 v2, 4, v0
    v_xor_b32 v2, v2, v1
    v_lshlrev_b32 v2, 4, v2
    v_lshl_add_u32 v4, v1, 10, v2
    v_xor_b32 v5, 64, v4
    v_xor_b32 v6, 128, v4
    v_xor_b32 v7, 192, v4
    v_lshrrev_b32 v120, 4, v0
    v_bfe_u32 v1, v0, 2, 1
    v_lshl_add_u32 v120, v1, 2, v120
    v_and_b32 v1, 3, v0
    v_lshl_add_u32 v120, v1, 3, v120
    v_bfe_u32 v1, v0, 3, 1
    v_lshl_add_u32 v120, v1, 5, v120
    v_lshlrev_b32 v120, 1, v120
    v_add_u32 v120, 147712, v120
    v_mov_b32 v121, 155904
    v_mov_b32 v112, 0xff7fffff
    v_mov_b32 v113, 0
    v_mov_b32 v123, 0
    v_mov_b32 v125, 156672
    s_mov_b32 s26, 0
    s_mov_b32 s25, 0x8000
    s_mov_b32 s27, 12
    s_mov_b32 s30, 0x3fb8aa3b
    v_lshlrev_b32 v8, 3, v0
    v_add_u32 v8, 156928, v8
    v_lshlrev_b32 v9, 2, v0
    v_add_u32 v9, 158976, v9
    v_and_b32 v10, 48, v0
    v_add_u32 v10, 158976, v10
    s_cmp_ge_i32 s26, 4
    s_cbranch_scc1 L_go14
L_poll15:
    s_sub_u32 s7, s7, 1
    s_cbranch_scc1 L_end
    s_sleep 1
    ds_read_b32 v1, v121
    s_waitcnt lgkmcnt(0)
    v_readfirstlane_b32 s26, v1
    s_cmp_ge_i32 s26, 4
    s_cbranch_scc0 L_poll15
L_go14:
    ds_read_b128 v[128:131], v4 offset:0
    ds_read_b128 v[132:135], v5 offset:0
    ds_read_b128 v[136:139], v6 offset:0
    ds_read_b128 v[140:143], v7 offset:0
    ds_read_b128 v[144:147], v4 offset:256
    ds_read_b128 v[148:151], v5 offset:256
    ds_read_b128 v[152:155], v6 offset:256
    ds_read_b128 v[156:159], v7 offset:256
    ds_read_b128 v[160:163], v4 offset:512
    ds_read_b128 v[164:167], v5 offset:512
    ds_read_b128 v[168:171], v6 offset:512
    ds_read_b128 v[172:175], v7 offset:512
    ds_read_b128 v[176:179], v4 offset:768
    ds_read_b128 v[180:183], v5 offset:768
    ds_read_b128 v[184:187], v6 offset:768
    ds_read_b128 v[188:191], v7 offset:768
    v_add_u32 v123, 1, v123
    s_waitcnt lgkmcnt(0)
    ds_write_b32 v122, v123
    s_cmp_ge_i32 s26, 8
    s_cbranch_scc1 L_go16
L_poll17:
    s_sub_u32 s7, s7, 1
    s_cbranch_scc1 L_end
    s_sleep 1
    ds_read_b32 v1, v121
    s_waitcnt lgkmcnt(0)
    v_readfirstlane_b32 s26, v1
    s_cmp_ge_i32 s26, 8
    s_cbranch_scc0 L_poll17
L_go16:
    ds_read_b128 v[192:195], v4 offset:16384
    ds_read_b128 v[196:199], v5 offset:16384
    ds_read_b128 v[200:203], v6 offset:16384
    ds_read_b128 v[204:207], v7 offset:16384
    ds_read_b128 v[208:211], v4 offset:16640
    ds_read_b128 v[212:215], v5 offset:16640
    ds_read_b128 v[216:219], v6 offset:16640
    ds_read_b128 v[220:223], v7 offset:16640
    ds_read_b128 v[224:227], v4 offset:16896
    ds_read_b128 v[228:231], v5 offset:16896
    ds_read_b128 v[232:235], v6 offset:16896
    ds_read_b128 v[236:239], v7 offset:16896
    ds_read_b128 v[240:243], v4 offset:17152
    ds_read_b128 v[244:247], v5 offset:17152
    ds_read_b128 v[248:251], v6 offset:17152
    ds_read_b128 v[252:255], v7 offset:17152
    v_add_u32 v123, 1, v123
    s_waitcnt lgkmcnt(0)
    ds_write_b32 v122, v123
    s_cmp_ge_i32 s26, 12
    s_cbranch_scc1 L_go18
L_poll19:
    s_sub_u32 s7, s7, 1
    s_cbranch_scc1 L_end
    s_sleep 1
    ds_read_b32 v1, v121
    s_waitcnt lgkmcnt(0)
    v_readfirstlane_b32 s26, v1
    s_cmp_ge_i32 s26, 12
    s_cbranch_scc0 L_poll19
L_go18:
    ds_read_b128 v[48:51], v4 offset:32768
    ds_read_b128 v[52:55], v5 offset:32768
    ds_read_b128 v[56:59], v6 offset:32768
    ds_read_b128 v[60:63], v7 offset:32768
    ds_read_b128 v[64:67], v4 offset:33024
    ds_read_b128 v[68:71], v5 offset:33024
    ds_read_b128 v[72:75], v6 offset:33024
    ds_read_b128 v[76:79], v7 offset:33024
    ds_read_b128 v[80:83], v4 offset:33280
    ds_read_b128 v[84:87], v5 offset:33280
    ds_read_b128 v[88:91], v6 offset:33280
    ds_read_b128 v[92:95], v7 offset:33280
    ds_read_b128 v[96:99], v4 offset:33536
    ds_read_b128 v[100:103], v5 offset:33536
    ds_read_b128 v[104:107], v6 offset:33536
    ds_read_b128 v[108:111], v7 offset:33536
    v_add_u32 v123, 1, v123
    s_waitcnt lgkmcnt(0)
    ds_write_b32 v122, v123
L_poll21:
    s_sub_u32 s7, s7, 1
    s_cbranch_scc1 L_end
    s_sleep 1
    ds_read_b32 v1, v125
    s_waitcnt lgkmcnt(0)
    v_readfirstlane_b32 s29, v1
    s_cmp_ge_i32 s29, 4
    s_cbranch_scc0 L_poll21
L_go20:
    ds_read_b64 v[32:33], v8 offset:0
    ds_read_b64 v[34:35], v8 offset:512
    ds_read_b64 v[36:37], v8 offset:1024
    ds_read_b64 v[38:39], v8 offset:1536
    s_waitcnt lgkmcnt(0)
    v_add_f32 v32, v32, v34
    v_add_f32 v33, v33, v35
    v_add_f32 v36, v36, v38
    v_add_f32 v37, v37, v39
    v_add_f32 v32, v32, v36
    v_add_f32 v33, v33, v37
    v_cvt_pk_bf16_f32 v32, v32, v33
    ds_write_b32 v9, v32
    ds_read_b128 v[16:19], v10 offset:0
    ds_read_b128 v[20:23], v10 offset:64
    ds_read_b128 v[24:27], v10 offset:128
    ds_read_b128 v[28:31], v10 offset:192
    s_waitcnt lgkmcnt(0)
    s_branch L_k_mfma
    .p2align 3
L_k_loop:
    v_add_u32 v8, s25, v4
    v_add_u32 v9, s25, v5
    v_add_u32 v10, s25, v6
    v_add_u32 v11, s25, v7
    s_cmp_ge_i32 s26, s27
    s_cbranch_scc1 L_go22
L_poll23:
    s_sub_u32 s7, s7, 1
    s_cbranch_scc1 L_end
    ds_read_b32 v1, v121
    s_waitcnt lgkmcnt(0)
    v_readfirstlane_b32 s26, v1
    s_cmp_ge_i32 s26, s27
    s_cbranch_scc0 L_poll23
L_go22:
    ds_read_b128 v[48:51], v8 offset:0
    ds_read_b128 v[52:55], v9 offset:0
    ds_read_b128 v[56:59], v10 offset:0
    ds_read_b128 v[60:63], v11 offset:0
    ds_read_b128 v[64:67], v8 offset:256
    ds_read_b128 v[68:71], v9 offset:256
    ds_read_b128 v[72:75], v10 offset:256
    ds_read_b128 v[76:79], v11 offset:256
    ds_read_b128 v[80:83], v8 offset:512
    ds_read_b128 v[84:87], v9 offset:512
    ds_read_b128 v[88:91], v10 offset:512
    ds_read_b128 v[92:95], v11 offset:512
    ds_read_b128 v[96:99], v8 offset:768
    ds_read_b128 v[100:103], v9 offset:768
    ds_read_b128 v[104:107], v10 offset:768
    ds_read_b128 v[108:111], v11 offset:768
    v_add_u32 v123, 1, v123
L_k_mfma:
    s_waitcnt lgkmcnt(12)
    v_mfma_f32_16x16x32_bf16 v[32:35], v[16:19], v[48:51], 0
    v_mfma_f32_16x16x32_bf16 v[32:35], v[20:23], v[52:55], v[32:35]
    v_mfma_f32_16x16x32_bf16 v[32:35], v[24:27], v[56:59], v[32:35]
    v_mfma_f32_16x16x32_bf16 v[32:35], v[28:31], v[60:63], v[32:35]
    s_waitcnt lgkmcnt(8)
    v_mfma_f32_16x16x32_bf16 v[36:39], v[16:19], v[64:67], 0
    v_mfma_f32_16x16x32_bf16 v[36:39], v[20:23], v[68:71], v[36:39]
    v_mfma_f32_16x16x32_bf16 v[36:39], v[24:27], v[72:75], v[36:39]
    v_mfma_f32_16x16x32_bf16 v[36:39], v[28:31], v[76:79], v[36:39]
    s_waitcnt lgkmcnt(4)
    v_mfma_f32_16x16x32_bf16 v[40:43], v[16:19], v[80:83], 0
    v_mfma_f32_16x16x32_bf16 v[40:43], v[20:23], v[84:87], v[40:43]
    v_mfma_f32_16x16x32_bf16 v[40:43], v[24:27], v[88:91], v[40:43]
    v_mfma_f32_16x16x32_bf16 v[40:43], v[28:31], v[92:95], v[40:43]
    s_waitcnt lgkmcnt(0)
    ds_write_b32 v122, v123
    v_mfma_f32_16x16x32_bf16 v[44:47], v[16:19], v[96:99], 0
    v_mfma_f32_16x16x32_bf16 v[44:47], v[20:23], v[100:103], v[44:47]
    v_mfma_f32_16x16x32_bf16 v[44:47], v[24:27], v[104:107], v[44:47]
    v_mfma_f32_16x16x32_bf16 v[44:47], v[28:31], v[108:111], v[44:47]
    s_add_u32 s25, s25, 0x4000
    s_cmp_eq_u32 s25, 0x24000
    s_cselect_b32 s25, 0, s25
    s_add_i32 s27, s27, 4
    s_nop 3
    v_mov_b32_dpp v32, v36 quad_perm:[0,1,2,3] row_mask:0x2 bank_mask:0xf
    v_mov_b32_dpp v32, v40 quad_perm:[0,1,2,3] row_mask:0x4 bank_mask:0xf
    v_mov_b32_dpp v32, v44 quad_perm:[0,1,2,3] row_mask:0x8 bank_mask:0xf
    v_cvt_pk_bf16_f32 v32, v32, v32
    v_and_b32 v32, 0xffff0000, v32
    v_mul_f32 v32, 0x3db504f3, v32
    v_cvt_pk_bf16_f32 v32, v32, v32
    v_and_b32 v32, 0xffff0000, v32
    ds_write_b16_d16_hi v120, v32
    v_max_f32 v114, v112, v32
    v_sub_f32 v115, v112, v114
    v_sub_f32 v116, v32, v114
    v_mul_f32 v115, s30, v115
    v_mul_f32 v116, s30, v116
    v_exp_f32 v115, v115
    v_exp_f32 v116, v116
    v_mov_b32 v112, v114
    v_add_u32 v120, 0x80, v120
    v_fma_f32 v113, v113, v115, v116
    s_cmp_le_i32 s27, 256
    s_cbranch_scc1 L_k_loop
    s_cmp_lg_u32 s27, 260
    s_cbranch_scc1 L_k_parked0
    v_subrev_u32 v120, 0x2000, v120
    v_mov_b64 v[48:49], v[128:129]
    v_mov_b64 v[50:51], v[130:131]
    v_mov_b64 v[52:53], v[132:133]
    v_mov_b64 v[54:55], v[134:135]
    v_mov_b64 v[56:57], v[136:137]
    v_mov_b64 v[58:59], v[138:139]
    v_mov_b64 v[60:61], v[140:141]
    v_mov_b64 v[62:63], v[142:143]
    v_mov_b64 v[64:65], v[144:145]
    v_mov_b64 v[66:67], v[146:147]
    v_mov_b64 v[68:69], v[148:149]
    v_mov_b64 v[70:71], v[150:151]
    v_mov_b64 v[72:73], v[152:153]
    v_mov_b64 v[74:75], v[154:155]
    v_mov_b64 v[76:77], v[156:157]
    v_mov_b64 v[78:79], v[158:159]
    v_mov_b64 v[80:81], v[160:161]
    v_mov_b64 v[82:83], v[162:163]
    v_mov_b64 v[84:85], v[164:165]
    v_mov_b64 v[86:87], v[166:167]
    v_mov_b64 v[88:89], v[168:169]
    v_mov_b64 v[90:91], v[170:171]
    v_mov_b64 v[92:93], v[172:173]
    v_mov_b64 v[94:95], v[174:175]
    v_mov_b64 v[96:97], v[176:177]
    v_mov_b64 v[98:99], v[178:179]
    v_mov_b64 v[100:101], v[180:181]
    v_mov_b64 v[102:103], v[182:183]
    v_mov_b64 v[104:105], v[184:185]
    v_mov_b64 v[106:107], v[186:187]
    v_mov_b64 v[108:109], v[188:189]
    v_mov_b64 v[110:111], v[190:191]
    s_branch L_k_mfma
L_k_parked0:
    s_cmp_lg_u32 s27, 264
    s_cbranch_scc1 L_k_parked1
    v_mov_b64 v[48:49], v[192:193]
    v_mov_b64 v[50:51], v[194:195]
    v_mov_b64 v[52:53], v[196:197]
    v_mov_b64 v[54:55], v[198:199]
    v_mov_b64 v[56:57], v[200:201]
    v_mov_b64 v[58:59], v[202:203]
    v_mov_b64 v[60:61], v[204:205]
    v_mov_b64 v[62:63], v[206:207]
    v_mov_b64 v[64:65], v[208:209]
    v_mov_b64 v[66:67], v[210:211]
    v_mov_b64 v[68:69], v[212:213]
    v_mov_b64 v[70:71], v[214:215]
    v_mov_b64 v[72:73], v[216:217]
    v_mov_b64 v[74:75], v[218:219]
    v_mov_b64 v[76:77], v[220:221]
    v_mov_b64 v[78:79], v[222:223]
    v_mov_b64 v[80:81], v[224:225]
    v_mov_b64 v[82:83], v[226:227]
    v_mov_b64 v[84:85], v[228:229]
    v_mov_b64 v[86:87], v[230:231]
    v_mov_b64 v[88:89], v[232:233]
    v_mov_b64 v[90:91], v[234:235]
    v_mov_b64 v[92:93], v[236:237]
    v_mov_b64 v[94:95], v[238:239]
    v_mov_b64 v[96:97], v[240:241]
    v_mov_b64 v[98:99], v[242:243]
    v_mov_b64 v[100:101], v[244:245]
    v_mov_b64 v[102:103], v[246:247]
    v_mov_b64 v[104:105], v[248:249]
    v_mov_b64 v[106:107], v[250:251]
    v_mov_b64 v[108:109], v[252:253]
    v_mov_b64 v[110:111], v[254:255]
    s_branch L_k_mfma
L_k_parked1:
    s_mov_b32 s25, 16384
    v_subrev_u32 v120, 0x100, v120
    ds_read_u16 v117, v120
    v_mov_b32 v114, v112
    s_nop 1
    v_max_f32_dpp v114, v114, v114 row_ror:8 row_mask:0xf bank_mask:0xf
    s_nop 1
    v_max_f32_dpp v114, v114, v114 row_ror:4 row_mask:0xf bank_mask:0xf
    s_nop 1
    v_max_f32_dpp v114, v114, v114 row_ror:2 row_mask:0xf bank_mask:0xf
    s_nop 1
    v_max_f32_dpp v114, v114, v114 row_ror:1 row_mask:0xf bank_mask:0xf
    s_nop 1
    v_max_f32_dpp v114, v114, v114 row_bcast:15 row_mask:0xa bank_mask:0xf
    s_nop 1
    v_max_f32_dpp v114, v114, v114 row_bcast:31 row_mask:0xc bank_mask:0xf
    s_nop 0
    v_readlane_b32 s31, v114, 63
    s_nop 1
    v_subrev_f32 v115, s31, v112
    v_mul_f32 v115, s30, v115
    v_exp_f32 v115, v115
    s_nop 0
    v_mul_f32 v113, v113, v115
    s_nop 1
    v_add_f32_dpp v113, v113, v113 row_ror:8 row_mask:0xf bank_mask:0xf
    s_nop 1
    v_add_f32_dpp v113, v113, v113 row_ror:4 row_mask:0xf bank_mask:0xf
    s_nop 1
    v_add_f32_dpp v113, v113, v113 row_ror:2 row_mask:0xf bank_mask:0xf
    s_nop 1
    v_add_f32_dpp v113, v113, v113 row_ror:1 row_mask:0xf bank_mask:0xf
    s_nop 1
    v_add_f32_dpp v113, v113, v113 row_bcast:15 row_mask:0xa bank_mask:0xf
    s_nop 1
    v_add_f32_dpp v113, v113, v113 row_bcast:31 row_mask:0xc bank_mask:0xf
    s_bfe_u32 s91, s2, 0x20005
    s_lshl_b32 s91, s91, 6
    s_lshr_b32 s35, s2, 7
    s_lshl_b32 s35, s35, 3
    s_or_b32 s91, s91, s35
    v_rcp_f32 v113, v113
    s_nop 0
    v_readlane_b32 s32, v113, 63
    v_lshrrev_b32 v1, 2, v0
    v_lshlrev_b32 v119, 8, v1
    v_and_b32 v1, 7, v1
    v_lshl_add_u32 v119, v1, 5, v119
    v_and_b32 v1, 3, v0
    v_lshl_add_u32 v119, v1, 3, v119
    v_and_b32 v118, 48, v0
    v_add_u32 v118, 147456, v118
    v_lshlrev_b32 v126, 2, v0
    v_xor_b32 v126, s91, v126
    v_bfe_u32 v1, v126, 2, 1
    v_bfe_u32 v2, v126, 3, 2
    v_and_b32 v126, 0xe0, v126
    v_lshl_add_u32 v126, v1, 4, v126
    v_lshl_add_u32 v126, v2, 2, v126
    v_add_u32 v126, 159232, v126
    s_mov_b32 s27, 258
    s_waitcnt lgkmcnt(0)
    v_mov_b64 v[16:17], 0
    v_mov_b64 v[18:19], 0
    v_mov_b64 v[20:21], 0
    v_mov_b64 v[22:23], 0
    v_mov_b64 v[24:25], 0
    v_mov_b64 v[26:27], 0
    v_mov_b64 v[28:29], 0
    v_mov_b64 v[30:31], 0
    v_mov_b64 v[32:33], 0
    v_mov_b64 v[34:35], 0
    v_mov_b64 v[36:37], 0
    v_mov_b64 v[38:39], 0
    v_mov_b64 v[40:41], 0
    v_mov_b64 v[42:43], 0
    v_mov_b64 v[44:45], 0
    v_mov_b64 v[46:47], 0
    v_lshlrev_b32 v117, 16, v117
    v_subrev_f32 v117, s31, v117
    v_mul_f32 v117, s30, v117
    v_exp_f32 v117, v117
    s_nop 0
    v_mul_f32 v117, s32, v117
    v_cvt_pk_bf16_f32 v117, v117, v117
    ds_write_b16 v120, v117
    v_add_u32 v120, 0x80, v120
    v_add_u32 v112, s25, v119
    v_xor_b32 v113, 32, v112
    v_xor_b32 v114, 64, v112
    v_xor_b32 v115, 96, v112
    v_xor_b32 v116, 128, v112
    v_xor_b32 v124, 160, v112
    v_xor_b32 v125, 192, v112
    v_xor_b32 v127, 224, v112
    s_branch L_v_poll0
    .p2align 3
L_v_loop:
    v_add_u32 v112, s25, v119
    v_xor_b32 v113, 32, v112
    v_xor_b32 v114, 64, v112
    v_xor_b32 v115, 96, v112
    v_xor_b32 v116, 128, v112
    v_xor_b32 v124, 160, v112
    v_xor_b32 v125, 192, v112
    v_xor_b32 v127, 224, v112
    s_cmp_ge_i32 s26, s27
    s_cbranch_scc1 L_v_fast0
    s_waitcnt lgkmcnt(14)
    v_mfma_f32_16x16x32_bf16 v[16:19], v[12:15], v[80:83], v[16:19]
    s_waitcnt lgkmcnt(12)
    v_mfma_f32_16x16x32_bf16 v[20:23], v[12:15], v[84:87], v[20:23]
    s_waitcnt lgkmcnt(10)
    v_mfma_f32_16x16x32_bf16 v[24:27], v[12:15], v[88:91], v[24:27]
    s_waitcnt lgkmcnt(8)
    v_mfma_f32_16x16x32_bf16 v[28:31], v[12:15], v[92:95], v[28:31]
    s_waitcnt lgkmcnt(6)
    v_mfma_f32_16x16x32_bf16 v[32:35], v[12:15], v[96:99], v[32:35]
    s_waitcnt lgkmcnt(4)
    v_mfma_f32_16x16x32_bf16 v[36:39], v[12:15], v[100:103], v[36:39]
    s_waitcnt lgkmcnt(2)
    v_mfma_f32_16x16x32_bf16 v[40:43], v[12:15], v[104:107], v[40:43]
    s_waitcnt lgkmcnt(0)
    v_mfma_f32_16x16x32_bf16 v[44:47], v[12:15], v[108:111], v[44:47]
    ds_write_b32 v122, v123
L_v_poll0:
L_poll25:
    s_sub_u32 s7, s7, 1
    s_cbranch_scc1 L_end
    ds_read_b32 v1, v121
    s_waitcnt lgkmcnt(0)
    v_readfirstlane_b32 s26, v1
    s_cmp_ge_i32 s26, s27
    s_cbranch_scc0 L_poll25
L_go24:
    ds_read_b128 v[8:11], v118 offset:0
    ds_read_u16 v117, v120
    ds_read_b64_tr_b16 v[48:49], v112 offset:0
    ds_read_b64_tr_b16 v[50:51], v112 offset:4096
    ds_read_b64_tr_b16 v[52:53], v113 offset:0
    ds_read_b64_tr_b16 v[54:55], v113 offset:4096
    ds_read_b64_tr_b16 v[56:57], v114 offset:0
    ds_read_b64_tr_b16 v[58:59], v114 offset:4096
    ds_read_b64_tr_b16 v[60:61], v115 offset:0
    ds_read_b64_tr_b16 v[62:63], v115 offset:4096
    ds_read_b64_tr_b16 v[64:65], v116 offset:0
    ds_read_b64_tr_b16 v[66:67], v116 offset:4096
    ds_read_b64_tr_b16 v[68:69], v124 offset:0
    ds_read_b64_tr_b16 v[70:71], v124 offset:4096
    ds_read_b64_tr_b16 v[72:73], v125 offset:0
    ds_read_b64_tr_b16 v[74:75], v125 offset:4096
    ds_read_b64_tr_b16 v[76:77], v127 offset:0
    ds_read_b64_tr_b16 v[78:79], v127 offset:4096
    s_branch L_v_next0
L_v_fast0:
    ds_read_b128 v[8:11], v118 offset:0
    ds_read_u16 v117, v120
    s_waitcnt lgkmcnt(14)
    v_mfma_f32_16x16x32_bf16 v[16:19], v[12:15], v[80:83], v[16:19]
    ds_read_b64_tr_b16 v[48:49], v112 offset:0
    ds_read_b64_tr_b16 v[50:51], v112 offset:4096
    s_waitcnt lgkmcnt(14)
    v_mfma_f32_16x16x32_bf16 v[20:23], v[12:15], v[84:87], v[20:23]
    ds_read_b64_tr_b16 v[52:53], v113 offset:0
    ds_read_b64_tr_b16 v[54:55], v113 offset:4096
    s_waitcnt lgkmcnt(14)
    v_mfma_f32_16x16x32_bf16 v[24:27], v[12:15], v[88:91], v[24:27]
    ds_read_b64_tr_b16 v[56:57], v114 offset:0
    ds_read_b64_tr_b16 v[58:59], v114 offset:4096
    s_waitcnt lgkmcnt(14)
    v_mfma_f32_16x16x32_bf16 v[28:31], v[12:15], v[92:95], v[28:31]
    ds_read_b64_tr_b16 v[60:61], v115 offset:0
    ds_read_b64_tr_b16 v[62:63], v115 offset:4096
    s_waitcnt lgkmcnt(14)
    v_mfma_f32_16x16x32_bf16 v[32:35], v[12:15], v[96:99], v[32:35]
    ds_read_b64_tr_b16 v[64:65], v116 offset:0
    ds_read_b64_tr_b16 v[66:67], v116 offset:4096
    s_waitcnt lgkmcnt(14)
    v_mfma_f32_16x16x32_bf16 v[36:39], v[12:15], v[100:103], v[36:39]
    ds_read_b64_tr_b16 v[68:69], v124 offset:0
    ds_read_b64_tr_b16 v[70:71], v124 offset:4096
    s_waitcnt lgkmcnt(14)
    v_mfma_f32_16x16x32_bf16 v[40:43], v[12:15], v[104:107], v[40:43]
    ds_read_b64_tr_b16 v[72:73], v125 offset:0
    ds_read_b64_tr_b16 v[74:75], v125 offset:4096
    s_waitcnt lgkmcnt(14)
    v_mfma_f32_16x16x32_bf16 v[44:47], v[12:15], v[108:111], v[44:47]
    ds_read_b64_tr_b16 v[76:77], v127 offset:0
    ds_read_b64_tr_b16 v[78:79], v127 offset:4096
    ds_write_b32 v122, v123
L_v_next0:
    s_add_i32 s27, s27, 2
    s_cmp_eq_u32 s27, 512
    s_cbranch_scc1 L_v_last
    s_cmp_ge_i32 s26, s27
    s_cbranch_scc1 L_v_fast1
    s_waitcnt lgkmcnt(14)
    v_mfma_f32_16x16x32_bf16 v[16:19], v[8:11], v[48:51], v[16:19]
    s_waitcnt lgkmcnt(12)
    v_mfma_f32_16x16x32_bf16 v[20:23], v[8:11], v[52:55], v[20:23]
    s_waitcnt lgkmcnt(10)
    v_mfma_f32_16x16x32_bf16 v[24:27], v[8:11], v[56:59], v[24:27]
    s_waitcnt lgkmcnt(8)
    v_mfma_f32_16x16x32_bf16 v[28:31], v[8:11], v[60:63], v[28:31]
    s_waitcnt lgkmcnt(6)
    v_mfma_f32_16x16x32_bf16 v[32:35], v[8:11], v[64:67], v[32:35]
    s_waitcnt lgkmcnt(4)
    v_mfma_f32_16x16x32_bf16 v[36:39], v[8:11], v[68:71], v[36:39]
    s_waitcnt lgkmcnt(2)
    v_mfma_f32_16x16x32_bf16 v[40:43], v[8:11], v[72:75], v[40:43]
    s_waitcnt lgkmcnt(0)
    v_mfma_f32_16x16x32_bf16 v[44:47], v[8:11], v[76:79], v[44:47]
L_v_poll1:
L_poll27:
    s_sub_u32 s7, s7, 1
    s_cbranch_scc1 L_end
    ds_read_b32 v1, v121
    s_waitcnt lgkmcnt(0)
    v_readfirstlane_b32 s26, v1
    s_cmp_ge_i32 s26, s27
    s_cbranch_scc0 L_poll27
L_go26:
    ds_read_b128 v[12:15], v118 offset:64
    ds_read_b64_tr_b16 v[80:81], v112 offset:8192
    ds_read_b64_tr_b16 v[82:83], v112 offset:12288
    ds_read_b64_tr_b16 v[84:85], v113 offset:8192
    ds_read_b64_tr_b16 v[86:87], v113 offset:12288
    ds_read_b64_tr_b16 v[88:89], v114 offset:8192
    ds_read_b64_tr_b16 v[90:91], v114 offset:12288
    ds_read_b64_tr_b16 v[92:93], v115 offset:8192
    ds_read_b64_tr_b16 v[94:95], v115 offset:12288
    ds_read_b64_tr_b16 v[96:97], v116 offset:8192
    ds_read_b64_tr_b16 v[98:99], v116 offset:12288
    ds_read_b64_tr_b16 v[100:101], v124 offset:8192
    ds_read_b64_tr_b16 v[102:103], v124 offset:12288
    ds_read_b64_tr_b16 v[104:105], v125 offset:8192
    ds_read_b64_tr_b16 v[106:107], v125 offset:12288
    ds_read_b64_tr_b16 v[108:109], v127 offset:8192
    ds_read_b64_tr_b16 v[110:111], v127 offset:12288
    s_branch L_v_next1
L_v_fast1:
    ds_read_b128 v[12:15], v118 offset:64
    s_waitcnt lgkmcnt(14)
    v_mfma_f32_16x16x32_bf16 v[16:19], v[8:11], v[48:51], v[16:19]
    ds_read_b64_tr_b16 v[80:81], v112 offset:8192
    ds_read_b64_tr_b16 v[82:83], v112 offset:12288
    s_waitcnt lgkmcnt(14)
    v_mfma_f32_16x16x32_bf16 v[20:23], v[8:11], v[52:55], v[20:23]
    ds_read_b64_tr_b16 v[84:85], v113 offset:8192
    ds_read_b64_tr_b16 v[86:87], v113 offset:12288
    s_waitcnt lgkmcnt(14)
    v_mfma_f32_16x16x32_bf16 v[24:27], v[8:11], v[56:59], v[24:27]
    ds_read_b64_tr_b16 v[88:89], v114 offset:8192
    ds_read_b64_tr_b16 v[90:91], v114 offset:12288
    s_waitcnt lgkmcnt(14)
    v_mfma_f32_16x16x32_bf16 v[28:31], v[8:11], v[60:63], v[28:31]
    ds_read_b64_tr_b16 v[92:93], v115 offset:8192
    ds_read_b64_tr_b16 v[94:95], v115 offset:12288
    s_waitcnt lgkmcnt(14)
    v_mfma_f32_16x16x32_bf16 v[32:35], v[8:11], v[64:67], v[32:35]
    ds_read_b64_tr_b16 v[96:97], v116 offset:8192
    ds_read_b64_tr_b16 v[98:99], v116 offset:12288
    s_waitcnt lgkmcnt(14)
    v_mfma_f32_16x16x32_bf16 v[36:39], v[8:11], v[68:71], v[36:39]
    ds_read_b64_tr_b16 v[100:101], v124 offset:8192
    ds_read_b64_tr_b16 v[102:103], v124 offset:12288
    s_waitcnt lgkmcnt(14)
    v_mfma_f32_16x16x32_bf16 v[40:43], v[8:11], v[72:75], v[40:43]
    ds_read_b64_tr_b16 v[104:105], v125 offset:8192
    ds_read_b64_tr_b16 v[106:107], v125 offset:12288
    s_waitcnt lgkmcnt(14)
    v_mfma_f32_16x16x32_bf16 v[44:47], v[8:11], v[76:79], v[44:47]
    ds_read_b64_tr_b16 v[108:109], v127 offset:8192
    ds_read_b64_tr_b16 v[110:111], v127 offset:12288
L_v_next1:
    s_add_i32 s27, s27, 2
    v_lshlrev_b32 v117, 16, v117
    v_subrev_f32 v117, s31, v117
    v_mul_f32 v117, s30, v117
    v_exp_f32 v117, v117
    s_nop 0
    v_mul_f32 v117, s32, v117
    v_cvt_pk_bf16_f32 v117, v117, v117
    ds_write_b16 v120, v117
    v_add_u32 v120, 0x80, v120
    v_add_u32 v118, 0x80, v118
    v_add_u32 v123, 1, v123
    s_add_u32 s25, s25, 0x4000
    s_cmp_eq_u32 s25, 0x24000
    s_cselect_b32 s25, 0, s25
    s_branch L_v_loop
L_v_last:
    s_waitcnt lgkmcnt(14)
    v_mfma_f32_16x16x32_bf16 v[16:19], v[8:11], v[48:51], v[16:19]
    s_waitcnt lgkmcnt(12)
    v_mfma_f32_16x16x32_bf16 v[20:23], v[8:11], v[52:55], v[20:23]
    s_waitcnt lgkmcnt(10)
    v_mfma_f32_16x16x32_bf16 v[24:27], v[8:11], v[56:59], v[24:27]
    s_waitcnt lgkmcnt(8)
    v_mfma_f32_16x16x32_bf16 v[28:31], v[8:11], v[60:63], v[28:31]
    s_waitcnt lgkmcnt(6)
    v_mfma_f32_16x16x32_bf16 v[32:35], v[8:11], v[64:67], v[32:35]
    s_waitcnt lgkmcnt(4)
    v_mfma_f32_16x16x32_bf16 v[36:39], v[8:11], v[68:71], v[36:39]
    s_waitcnt lgkmcnt(2)
    v_mfma_f32_16x16x32_bf16 v[40:43], v[8:11], v[72:75], v[40:43]
    s_waitcnt lgkmcnt(0)
    v_mfma_f32_16x16x32_bf16 v[44:47], v[8:11], v[76:79], v[44:47]
    ds_read_b128 v[12:15], v118 offset:64
    s_cmp_ge_i32 s26, 511
    s_cbranch_scc1 L_go28
L_poll29:
    s_sub_u32 s7, s7, 1
    s_cbranch_scc1 L_end
    ds_read_b32 v1, v121
    s_waitcnt lgkmcnt(0)
    v_readfirstlane_b32 s26, v1
    s_cmp_ge_i32 s26, 511
    s_cbranch_scc0 L_poll29
L_go28:
    ds_read_b64_tr_b16 v[80:81], v112 offset:8192
    ds_read_b64_tr_b16 v[84:85], v113 offset:8192
    ds_read_b64_tr_b16 v[88:89], v114 offset:8192
    ds_read_b64_tr_b16 v[92:93], v115 offset:8192
    ds_read_b64_tr_b16 v[96:97], v116 offset:8192
    ds_read_b64_tr_b16 v[100:101], v124 offset:8192
    ds_read_b64_tr_b16 v[104:105], v125 offset:8192
    ds_read_b64_tr_b16 v[108:109], v127 offset:8192
    s_barrier
    ds_read_b64_tr_b16 v[82:83], v112 offset:12288
    ds_read_b64_tr_b16 v[86:87], v113 offset:12288
    ds_read_b64_tr_b16 v[90:91], v114 offset:12288
    ds_read_b64_tr_b16 v[94:95], v115 offset:12288
    ds_read_b64_tr_b16 v[98:99], v116 offset:12288
    ds_read_b64_tr_b16 v[102:103], v124 offset:12288
    ds_read_b64_tr_b16 v[106:107], v125 offset:12288
    ds_read_b64_tr_b16 v[110:111], v127 offset:12288
    s_waitcnt lgkmcnt(7)
    v_mfma_f32_16x16x32_bf16 v[16:19], v[12:15], v[80:83], v[16:19]
    s_waitcnt lgkmcnt(6)
    v_mfma_f32_16x16x32_bf16 v[20:23], v[12:15], v[84:87], v[20:23]
    s_waitcnt lgkmcnt(5)
    v_mfma_f32_16x16x32_bf16 v[24:27], v[12:15], v[88:91], v[24:27]
    s_waitcnt lgkmcnt(4)
    v_mfma_f32_16x16x32_bf16 v[28:31], v[12:15], v[92:95], v[28:31]
    s_waitcnt lgkmcnt(3)
    v_mfma_f32_16x16x32_bf16 v[32:35], v[12:15], v[96:99], v[32:35]
    s_waitcnt lgkmcnt(2)
    v_mfma_f32_16x16x32_bf16 v[36:39], v[12:15], v[100:103], v[36:39]
    s_waitcnt lgkmcnt(1)
    v_mfma_f32_16x16x32_bf16 v[40:43], v[12:15], v[104:107], v[40:43]
    v_mov_b32_dpp v16, v24 quad_perm:[0,1,2,3] row_mask:0x2 bank_mask:0xf
    s_waitcnt lgkmcnt(0)
    v_mfma_f32_16x16x32_bf16 v[44:47], v[12:15], v[108:111], v[44:47]
    v_mov_b32_dpp v20, v28 quad_perm:[0,1,2,3] row_mask:0x2 bank_mask:0xf
    v_mov_b32_dpp v16, v32 quad_perm:[0,1,2,3] row_mask:0x4 bank_mask:0xf
    s_nop 0
    v_mov_b32_dpp v20, v36 quad_perm:[0,1,2,3] row_mask:0x4 bank_mask:0xf
    s_nop 0
    v_mov_b32_dpp v16, v40 quad_perm:[0,1,2,3] row_mask:0x8 bank_mask:0xf
    s_nop 1
    v_mov_b32_dpp v20, v44 quad_perm:[0,1,2,3] row_mask:0x8 bank_mask:0xf
    v_cvt_pk_bf16_f32 v16, v16, v20
    ds_write_b32 v126, v16
    s_waitcnt lgkmcnt(0)
    s_barrier
    s_endpgm
    .p2align 3
L_ld_d0:
    s_add_u32 m0, s25, 0
    s_xor_b32 s23, s24, 0
    s_waitcnt vmcnt(15)
    buffer_load_dwordx4 v16, s[16:19], s23 offen offset:0 nt lds
    s_waitcnt vmcnt(15)
    buffer_load_dwordx4 v17, s[16:19], s23 offen offset:1024 nt lds
    s_waitcnt vmcnt(15)
    buffer_load_dwordx4 v18, s[16:19], s23 offen offset:2048 nt lds
    s_waitcnt vmcnt(15)
    buffer_load_dwordx4 v19, s[16:19], s23 offen offset:3072 nt lds
    s_add_i32 s30, s28, -3
    v_mov_b32 v4, s30
    ds_write_b32 v2, v4
    s_add_u32 m0, s25, 4096
    s_xor_b32 s23, s24, 8192
    s_waitcnt vmcnt(15)
    buffer_load_dwordx4 v20, s[16:19], s23 offen offset:0 nt lds
    s_waitcnt vmcnt(15)
    buffer_load_dwordx4 v21, s[16:19], s23 offen offset:1024 nt lds
    s_waitcnt vmcnt(15)
    buffer_load_dwordx4 v22, s[16:19], s23 offen offset:2048 nt lds
    s_waitcnt vmcnt(15)
    buffer_load_dwordx4 v23, s[16:19], s23 offen offset:3072 nt lds
    s_add_i32 s30, s28, -2
    v_mov_b32 v4, s30
    ds_write_b32 v2, v4
    s_add_u32 m0, s25, 8192
    s_xor_b32 s23, s24, 32768
    s_waitcnt vmcnt(15)
    buffer_load_dwordx4 v24, s[16:19], s23 offen offset:0 nt lds
    ds_read2st64_b32 v[6:7], v3 offset0:0 offset1:1
    s_waitcnt vmcnt(15)
    buffer_load_dwordx4 v25, s[16:19], s23 offen offset:1024 nt lds
    s_waitcnt vmcnt(15)
    buffer_load_dwordx4 v26, s[16:19], s23 offen offset:2048 nt lds
    s_waitcnt vmcnt(15)
    buffer_load_dwordx4 v27, s[16:19], s23 offen offset:3072 nt lds
    s_add_i32 s30, s28, -1
    v_mov_b32 v4, s30
    ds_write_b32 v2, v4
    s_add_u32 m0, s25, 12288
    s_xor_b32 s23, s24, 40960
    s_waitcnt vmcnt(15)
    buffer_load_dwordx4 v28, s[16:19], s23 offen offset:0 nt lds
    s_waitcnt lgkmcnt(0)
    v_readfirstlane_b32 s26, v6
    v_readfirstlane_b32 s31, v7
    s_waitcnt vmcnt(15)
    buffer_load_dwordx4 v29, s[16:19], s23 offen offset:1024 nt lds
    s_waitcnt vmcnt(15)
    buffer_load_dwordx4 v30, s[16:19], s23 offen offset:2048 nt lds
    s_waitcnt vmcnt(15)
    buffer_load_dwordx4 v31, s[16:19], s23 offen offset:3072 nt lds
    s_add_i32 s30, s28, 0
    v_mov_b32 v4, s30
    ds_write_b32 v2, v4
    s_branch L_ld_top
    .p2align 3
L_ld_d1:
    s_add_u32 m0, s25, 0
    s_xor_b32 s23, s24, 0
    s_waitcnt vmcnt(16)
    buffer_load_dwordx4 v16, s[16:19], s23 offen offset:0 nt lds
    s_add_i32 s30, s28, -4
    v_mov_b32 v4, s30
    ds_write_b32 v2, v4
    s_waitcnt vmcnt(16)
    buffer_load_dwordx4 v17, s[16:19], s23 offen offset:1024 nt lds
    s_waitcnt vmcnt(16)
    buffer_load_dwordx4 v18, s[16:19], s23 offen offset:2048 nt lds
    s_waitcnt vmcnt(16)
    buffer_load_dwordx4 v19, s[16:19], s23 offen offset:3072 nt lds
    s_add_u32 m0, s25, 4096
    s_xor_b32 s23, s24, 8192
    s_waitcnt vmcnt(16)
    buffer_load_dwordx4 v20, s[16:19], s23 offen offset:0 nt lds
    s_add_i32 s30, s28, -3
    v_mov_b32 v4, s30
    ds_write_b32 v2, v4
    s_waitcnt vmcnt(16)
    buffer_load_dwordx4 v21, s[16:19], s23 offen offset:1024 nt lds
    s_waitcnt vmcnt(16)
    buffer_load_dwordx4 v22, s[16:19], s23 offen offset:2048 nt lds
    s_waitcnt vmcnt(16)
    buffer_load_dwordx4 v23, s[16:19], s23 offen offset:3072 nt lds
    s_add_u32 m0, s25, 8192
    s_xor_b32 s23, s24, 32768
    s_waitcnt vmcnt(16)
    buffer_load_dwordx4 v24, s[16:19], s23 offen offset:0 nt lds
    s_add_i32 s30, s28, -2
    v_mov_b32 v4, s30
    ds_write_b32 v2, v4
    ds_read2st64_b32 v[6:7], v3 offset0:0 offset1:1
    s_waitcnt vmcnt(16)
    buffer_load_dwordx4 v25, s[16:19], s23 offen offset:1024 nt lds
    s_waitcnt vmcnt(16)
    buffer_load_dwordx4 v26, s[16:19], s23 offen offset:2048 nt lds
    s_waitcnt vmcnt(16)
    buffer_load_dwordx4 v27, s[16:19], s23 offen offset:3072 nt lds
    s_add_u32 m0, s25, 12288
    s_xor_b32 s23, s24, 40960
    s_waitcnt vmcnt(16)
    buffer_load_dwordx4 v28, s[16:19], s23 offen offset:0 nt lds
    s_add_i32 s30, s28, -1
    v_mov_b32 v4, s30
    ds_write_b32 v2, v4
    s_waitcnt lgkmcnt(0)
    v_readfirstlane_b32 s26, v6
    v_readfirstlane_b32 s31, v7
    s_waitcnt vmcnt(16)
    buffer_load_dwordx4 v29, s[16:19], s23 offen offset:1024 nt lds
    s_waitcnt vmcnt(16)
    buffer_load_dwordx4 v30, s[16:19], s23 offen offset:2048 nt lds
    s_waitcnt vmcnt(16)
    buffer_load_dwordx4 v31, s[16:19], s23 offen offset:3072 nt lds
    s_branch L_ld_top
    .p2align 3
L_ld_d2:
    s_add_u32 m0, s25, 0
    s_xor_b32 s23, s24, 0
    s_waitcnt vmcnt(17)
    buffer_load_dwordx4 v16, s[16:19], s23 offen offset:0 nt lds
    s_waitcnt vmcnt(17)
    buffer_load_dwordx4 v17, s[16:19], s23 offen offset:1024 nt lds
    s_add_i32 s30, s28, -4
    v_mov_b32 v4, s30
    ds_write_b32 v2, v4
    s_waitcnt vmcnt(17)
    buffer_load_dwordx4 v18, s[16:19], s23 offen offset:2048 nt lds
    s_waitcnt vmcnt(17)
    buffer_load_dwordx4 v19, s[16:19], s23 offen offset:3072 nt lds
    s_add_u32 m0, s25, 4096
    s_xor_b32 s23, s24, 8192
    s_waitcnt vmcnt(17)
    buffer_load_dwordx4 v20, s[16:19], s23 offen offset:0 nt lds
    s_waitcnt vmcnt(17)
    buffer_load_dwordx4 v21, s[16:19], s23 offen offset:1024 nt lds
    s_add_i32 s30, s28, -3
    v_mov_b32 v4, s30
    ds_write_b32 v2, v4
    s_waitcnt vmcnt(17)
    buffer_load_dwordx4 v22, s[16:19], s23 offen offset:2048 nt lds
    s_waitcnt vmcnt(17)
    buffer_load_dwordx4 v23, s[16:19], s23 offen offset:3072 nt lds
    s_add_u32 m0, s25, 8192
    s_xor_b32 s23, s24, 32768
    s_waitcnt vmcnt(17)
    buffer_load_dwordx4 v24, s[16:19], s23 offen offset:0 nt lds
    ds_read2st64_b32 v[6:7], v3 offset0:0 offset1:1
    s_waitcnt vmcnt(17)
    buffer_load_dwordx4 v25, s[16:19], s23 offen offset:1024 nt lds
    s_add_i32 s30, s28, -2
    v_mov_b32 v4, s30
    ds_write_b32 v2, v4
    s_waitcnt vmcnt(17)
    buffer_load_dwordx4 v26, s[16:19], s23 offen offset:2048 nt lds
    s_waitcnt vmcnt(17)
    buffer_load_dwordx4 v27, s[16:19], s23 offen offset:3072 nt lds
    s_add_u32 m0, s25, 12288
    s_xor_b32 s23, s24, 40960
    s_waitcnt vmcnt(17)
    buffer_load_dwordx4 v28, s[16:19], s23 offen offset:0 nt lds
    s_waitcnt lgkmcnt(0)
    v_readfirstlane_b32 s26, v6
    v_readfirstlane_b32 s31, v7
    s_waitcnt vmcnt(17)
    buffer_load_dwordx4 v29, s[16:19], s23 offen offset:1024 nt lds
    s_add_i32 s30, s28, -1
    v_mov_b32 v4, s30
    ds_write_b32 v2, v4
    s_waitcnt vmcnt(17)
    buffer_load_dwordx4 v30, s[16:19], s23 offen offset:2048 nt lds
    s_waitcnt vmcnt(17)
    buffer_load_dwordx4 v31, s[16:19], s23 offen offset:3072 nt lds
    s_branch L_ld_top
    .p2align 3
L_ld_d4:
    s_add_u32 m0, s25, 0
    s_xor_b32 s23, s24, 0
    s_waitcnt vmcnt(19)
    buffer_load_dwordx4 v16, s[16:19], s23 offen offset:0 nt lds
    s_waitcnt vmcnt(19)
    buffer_load_dwordx4 v17, s[16:19], s23 offen offset:1024 nt lds
    s_waitcnt vmcnt(19)
    buffer_load_dwordx4 v18, s[16:19], s23 offen offset:2048 nt lds
    s_waitcnt vmcnt(19)
    buffer_load_dwordx4 v19, s[16:19], s23 offen offset:3072 nt lds
    s_add_i32 s30, s28, -4
    v_mov_b32 v4, s30
    ds_write_b32 v2, v4
    s_add_u32 m0, s25, 4096
    s_xor_b32 s23, s24, 8192
    s_waitcnt vmcnt(19)
    buffer_load_dwordx4 v20, s[16:19], s23 offen offset:0 nt lds
    s_waitcnt vmcnt(19)
    buffer_load_dwordx4 v21, s[16:19], s23 offen offset:1024 nt lds
    s_waitcnt vmcnt(19)
    buffer_load_dwordx4 v22, s[16:19], s23 offen offset:2048 nt lds
    s_waitcnt vmcnt(19)
    buffer_load_dwordx4 v23, s[16:19], s23 offen offset:3072 nt lds
    s_add_i32 s30, s28, -3
    v_mov_b32 v4, s30
    ds_write_b32 v2, v4
    s_add_u32 m0, s25, 8192
    s_xor_b32 s23, s24, 32768
    s_waitcnt vmcnt(19)
    buffer_load_dwordx4 v24, s[16:19], s23 offen offset:0 nt lds
    ds_read2st64_b32 v[6:7], v3 offset0:0 offset1:1
    s_waitcnt vmcnt(19)
    buffer_load_dwordx4 v25, s[16:19], s23 offen offset:1024 nt lds
    s_waitcnt vmcnt(19)
    buffer_load_dwordx4 v26, s[16:19], s23 offen offset:2048 nt lds
    s_waitcnt vmcnt(19)
    buffer_load_dwordx4 v27, s[16:19], s23 offen offset:3072 nt lds
    s_add_i32 s30, s28, -2
    v_mov_b32 v4, s30
    ds_write_b32 v2, v4
    s_add_u32 m0, s25, 12288
    s_xor_b32 s23, s24, 40960
    s_waitcnt vmcnt(19)
    buffer_load_dwordx4 v28, s[16:19], s23 offen offset:0 nt lds
    s_waitcnt lgkmcnt(0)
    v_readfirstlane_b32 s26, v6
    v_readfirstlane_b32 s31, v7
    s_waitcnt vmcnt(19)
    buffer_load_dwordx4 v29, s[16:19], s23 offen offset:1024 nt lds
    s_waitcnt vmcnt(19)
    buffer_load_dwordx4 v30, s[16:19], s23 offen offset:2048 nt lds
    s_waitcnt vmcnt(19)
    buffer_load_dwordx4 v31, s[16:19], s23 offen offset:3072 nt lds
    s_add_i32 s30, s28, -1
    v_mov_b32 v4, s30
    ds_write_b32 v2, v4
    s_branch L_ld_top
    .p2align 3
L_ld_d5:
    s_add_u32 m0, s25, 0
    s_xor_b32 s23, s24, 0
    s_waitcnt vmcnt(21)
    buffer_load_dwordx4 v16, s[16:19], s23 offen offset:0 nt lds
    s_waitcnt vmcnt(21)
    buffer_load_dwordx4 v17, s[16:19], s23 offen offset:1024 nt lds
    s_add_i32 s30, s28, -5
    v_mov_b32 v4, s30
    ds_write_b32 v2, v4
    s_waitcnt vmcnt(21)
    buffer_load_dwordx4 v18, s[16:19], s23 offen offset:2048 nt lds
    s_waitcnt vmcnt(21)
    buffer_load_dwordx4 v19, s[16:19], s23 offen offset:3072 nt lds
    s_add_u32 m0, s25, 4096
    s_xor_b32 s23, s24, 8192
    s_waitcnt vmcnt(21)
    buffer_load_dwordx4 v20, s[16:19], s23 offen offset:0 nt lds
    s_waitcnt vmcnt(21)
    buffer_load_dwordx4 v21, s[16:19], s23 offen offset:1024 nt lds
    s_add_i32 s30, s28, -4
    v_mov_b32 v4, s30
    ds_write_b32 v2, v4
    s_waitcnt vmcnt(21)
    buffer_load_dwordx4 v22, s[16:19], s23 offen offset:2048 nt lds
    s_waitcnt vmcnt(21)
    buffer_load_dwordx4 v23, s[16:19], s23 offen offset:3072 nt lds
    s_add_u32 m0, s25, 8192
    s_xor_b32 s23, s24, 32768
    s_waitcnt vmcnt(21)
    buffer_load_dwordx4 v24, s[16:19], s23 offen offset:0 nt lds
    ds_read2st64_b32 v[6:7], v3 offset0:0 offset1:1
    s_waitcnt vmcnt(21)
    buffer_load_dwordx4 v25, s[16:19], s23 offen offset:1024 nt lds
    s_add_i32 s30, s28, -3
    v_mov_b32 v4, s30
    ds_write_b32 v2, v4
    s_waitcnt vmcnt(21)
    buffer_load_dwordx4 v26, s[16:19], s23 offen offset:2048 nt lds
    s_waitcnt vmcnt(21)
    buffer_load_dwordx4 v27, s[16:19], s23 offen offset:3072 nt lds
    s_add_u32 m0, s25, 12288
    s_xor_b32 s23, s24, 40960
    s_waitcnt vmcnt(21)
    buffer_load_dwordx4 v28, s[16:19], s23 offen offset:0 nt lds
    s_waitcnt lgkmcnt(0)
    v_readfirstlane_b32 s26, v6
    v_readfirstlane_b32 s31, v7
    s_waitcnt vmcnt(21)
    buffer_load_dwordx4 v29, s[16:19], s23 offen offset:1024 nt lds
    s_add_i32 s30, s28, -2
    v_mov_b32 v4, s30
    ds_write_b32 v2, v4
    s_waitcnt vmcnt(21)
    buffer_load_dwordx4 v30, s[16:19], s23 offen offset:2048 nt lds
    s_waitcnt vmcnt(21)
    buffer_load_dwordx4 v31, s[16:19], s23 offen offset:3072 nt lds
    s_branch L_ld_top
    .p2align 3
L_ld_d6:
    s_add_u32 m0, s25, 0
    s_xor_b32 s23, s24, 0
    s_waitcnt vmcnt(23)
    buffer_load_dwordx4 v16, s[16:19], s23 offen offset:0 nt lds
    s_waitcnt vmcnt(23)
    buffer_load_dwordx4 v17, s[16:19], s23 offen offset:1024 nt lds
    s_waitcnt vmcnt(23)
    buffer_load_dwordx4 v18, s[16:19], s23 offen offset:2048 nt lds
    s_waitcnt vmcnt(23)
    buffer_load_dwordx4 v19, s[16:19], s23 offen offset:3072 nt lds
    s_add_i32 s30, s28, -5
    v_mov_b32 v4, s30
    ds_write_b32 v2, v4
    s_add_u32 m0, s25, 4096
    s_xor_b32 s23, s24, 8192
    s_waitcnt vmcnt(23)
    buffer_load_dwordx4 v20, s[16:19], s23 offen offset:0 nt lds
    s_waitcnt vmcnt(23)
    buffer_load_dwordx4 v21, s[16:19], s23 offen offset:1024 nt lds
    s_waitcnt vmcnt(23)
    buffer_load_dwordx4 v22, s[16:19], s23 offen offset:2048 nt lds
    s_waitcnt vmcnt(23)
    buffer_load_dwordx4 v23, s[16:19], s23 offen offset:3072 nt lds
    s_add_i32 s30, s28, -4
    v_mov_b32 v4, s30
    ds_write_b32 v2, v4
    s_add_u32 m0, s25, 8192
    s_xor_b32 s23, s24, 32768
    s_waitcnt vmcnt(23)
    buffer_load_dwordx4 v24, s[16:19], s23 offen offset:0 nt lds
    ds_read2st64_b32 v[6:7], v3 offset0:0 offset1:1
    s_waitcnt vmcnt(23)
    buffer_load_dwordx4 v25, s[16:19], s23 offen offset:1024 nt lds
    s_waitcnt vmcnt(23)
    buffer_load_dwordx4 v26, s[16:19], s23 offen offset:2048 nt lds
    s_waitcnt vmcnt(23)
    buffer_load_dwordx4 v27, s[16:19], s23 offen offset:3072 nt lds
    s_add_i32 s30, s28, -3
    v_mov_b32 v4, s30
    ds_write_b32 v2, v4
    s_add_u32 m0, s25, 12288
    s_xor_b32 s23, s24, 40960
    s_waitcnt vmcnt(23)
    buffer_load_dwordx4 v28, s[16:19], s23 offen offset:0 nt lds
    s_waitcnt lgkmcnt(0)
    v_readfirstlane_b32 s26, v6
    v_readfirstlane_b32 s31, v7
    s_waitcnt vmcnt(23)
    buffer_load_dwordx4 v29, s[16:19], s23 offen offset:1024 nt lds
    s_waitcnt vmcnt(23)
    buffer_load_dwordx4 v30, s[16:19], s23 offen offset:2048 nt lds
    s_waitcnt vmcnt(23)
    buffer_load_dwordx4 v31, s[16:19], s23 offen offset:3072 nt lds
    s_add_i32 s30, s28, -2
    v_mov_b32 v4, s30
    ds_write_b32 v2, v4
    s_branch L_ld_top
    .p2align 3
L_ld_d7:
    s_add_u32 m0, s25, 0
    s_xor_b32 s23, s24, 0
    s_waitcnt vmcnt(26)
    buffer_load_dwordx4 v16, s[16:19], s23 offen offset:0 nt lds
    s_waitcnt vmcnt(26)
    buffer_load_dwordx4 v17, s[16:19], s23 offen offset:1024 nt lds
    s_waitcnt vmcnt(26)
    buffer_load_dwordx4 v18, s[16:19], s23 offen offset:2048 nt lds
    s_add_i32 s30, s28, -6
    v_mov_b32 v4, s30
    ds_write_b32 v2, v4
    s_waitcnt vmcnt(26)
    buffer_load_dwordx4 v19, s[16:19], s23 offen offset:3072 nt lds
    s_add_u32 m0, s25, 4096
    s_xor_b32 s23, s24, 8192
    s_waitcnt vmcnt(26)
    buffer_load_dwordx4 v20, s[16:19], s23 offen offset:0 nt lds
    s_waitcnt vmcnt(26)
    buffer_load_dwordx4 v21, s[16:19], s23 offen offset:1024 nt lds
    s_waitcnt vmcnt(26)
    buffer_load_dwordx4 v22, s[16:19], s23 offen offset:2048 nt lds
    s_add_i32 s30, s28, -5
    v_mov_b32 v4, s30
    ds_write_b32 v2, v4
    s_waitcnt vmcnt(26)
    buffer_load_dwordx4 v23, s[16:19], s23 offen offset:3072 nt lds
    s_add_u32 m0, s25, 8192
    s_xor_b32 s23, s24, 32768
    s_waitcnt vmcnt(26)
    buffer_load_dwordx4 v24, s[16:19], s23 offen offset:0 nt lds
    ds_read2st64_b32 v[6:7], v3 offset0:0 offset1:1
    s_waitcnt vmcnt(26)
    buffer_load_dwordx4 v25, s[16:19], s23 offen offset:1024 nt lds
    s_waitcnt vmcnt(26)
    buffer_load_dwordx4 v26, s[16:19], s23 offen offset:2048 nt lds
    s_add_i32 s30, s28, -4
    v_mov_b32 v4, s30
    ds_write_b32 v2, v4
    s_waitcnt vmcnt(26)
    buffer_load_dwordx4 v27, s[16:19], s23 offen offset:3072 nt lds
    s_add_u32 m0, s25, 12288
    s_xor_b32 s23, s24, 40960
    s_waitcnt vmcnt(26)
    buffer_load_dwordx4 v28, s[16:19], s23 offen offset:0 nt lds
    s_waitcnt lgkmcnt(0)
    v_readfirstlane_b32 s26, v6
    v_readfirstlane_b32 s31, v7
    s_waitcnt vmcnt(26)
    buffer_load_dwordx4 v29, s[16:19], s23 offen offset:1024 nt lds
    s_waitcnt vmcnt(26)
    buffer_load_dwordx4 v30, s[16:19], s23 offen offset:2048 nt lds
    s_add_i32 s30, s28, -3
    v_mov_b32 v4, s30
    ds_write_b32 v2, v4
    s_waitcnt vmcnt(26)
    buffer_load_dwordx4 v31, s[16:19], s23 offen offset:3072 nt lds
    s_branch L_ld_top
.section .rodata,"a"
.p2align 6
.amdhsa_kernel parallel_sum__mha_block_cached__dense_activation_silu__decode_kernel
  .amdhsa_next_free_vgpr 256
  .amdhsa_next_free_sgpr 100
  .amdhsa_accum_offset 256
  .amdhsa_group_segment_fixed_size 0
  .amdhsa_kernarg_size 88
  .amdhsa_user_sgpr_count 2
  .amdhsa_user_sgpr_kernarg_segment_ptr 1
  .amdhsa_system_sgpr_workgroup_id_x 1
  .amdhsa_float_denorm_mode_32 3
.end_amdhsa_kernel
```
